```python
import torch

def _softmax(x, axis=-1):
    return torch.softmax(x, dim=axis)
def _gelu(x):
    return torch.nn.functional.gelu(x, approximate="tanh")
def _silu(x):
    return torch.nn.functional.silu(x)
def _sigmoid(x):
    return torch.sigmoid(x)
def _layernorm(x, axis=-1, eps=1e-5):
    m = x.mean(dim=axis, keepdim=True)
    v = x.var(dim=axis, keepdim=True, unbiased=False)
    return (x - m) / torch.sqrt(v + eps)
def _scatter_add(tgt, idx, src, axis=0):
    return tgt.clone().index_add_(axis, idx, src)
def _segment_sum(src, seg, n):
    out = torch.zeros((n,) + src.shape[1:], dtype=src.dtype)
    return out.index_add_(0, seg, src)
def _pad(x, pw):
    flat = tuple(v for pair in reversed(pw) for v in pair)
    return torch.nn.functional.pad(x, flat)

kernel_name = 'sequential_preLN__sliding_block_cached__mixer_channel_mlp__decode'

def setup_inputs():

    _w = (lambda a: (lambda t: t.to(torch.bfloat16) if t.is_floating_point() else t)(torch.as_tensor(a)))
    def _A_setup():
        B, Sq, D = 2, 1, 576
        Hq, Hkv, Sk, Dh = 32, 16, 32768, 128
        assert Hq % Hkv == 0, (Hq, Hkv)
        return {
            "x": _w((lambda *s: torch.randn(*s, dtype=torch.bfloat16) * 0.05)(B, Sq, D)),
            "k_cache": _w((lambda *s: torch.randn(*s, dtype=torch.bfloat16) * 3.2)(B, Hkv, Sk, Dh)),
            "v_cache": _w((lambda *s: torch.randn(*s, dtype=torch.bfloat16) * 0.4)(B, Hkv, Sk, Dh)),
            "wq": _w((lambda *s: torch.randn(*s, dtype=torch.bfloat16) * 3.2)(D, Hq * Dh) * (D ** -0.5)),
            "wo": _w((lambda *s: torch.randn(*s, dtype=torch.bfloat16) * 0.4)(Hq * Dh, D) * ((Hq * Dh) ** -0.5)),
        }
    _A_in = _A_setup()

    def _B_setup():
        B, S, D, F = 2, 1, 576, 4608
        return {
            "x": _w((lambda *s: torch.randn(*s, dtype=torch.bfloat16) * 0.05)(B, S, D)),
            "w1": _w((lambda *s: torch.randn(*s, dtype=torch.bfloat16) * 3.2)(D, F) * (D ** -0.5)),
            "b1": _w((lambda *s: torch.randn(*s, dtype=torch.bfloat16) * 3.2)(F)),
            "w2": _w((lambda *s: torch.randn(*s, dtype=torch.bfloat16) * 0.8)(F, D) * (F ** -0.5)),
            "b2": _w((lambda *s: torch.randn(*s, dtype=torch.bfloat16) * 1.6)(D)),
        }
    _B_in = _B_setup()

    return {
        "A_x": _A_in["x"],
        "A_k_cache": _A_in["k_cache"],
        "A_v_cache": _A_in["v_cache"],
        "A_wq": _A_in["wq"],
        "A_wo": _A_in["wo"],
        "B_x": _B_in["x"],
        "B_w1": _B_in["w1"],
        "B_b1": _B_in["b1"],
        "B_w2": _B_in["w2"],
        "B_b2": _B_in["b2"],
    }

def reference(A_x, A_k_cache, A_v_cache, A_wq, A_wo, B_x, B_w1, B_b1, B_w2, B_b2):
    def _A_ref(x, k_cache, v_cache, wq, wo):
        B, Sq, D = x.shape
        Hq, Dh = 32, 128
        Hkv, Sk = k_cache.shape[1], k_cache.shape[2]
        W = min(4096, max(256, Sk // 4))
        rep = Hq // Hkv
        q = (lambda x, *d: x.permute(*d))((x @ wq).reshape(B, Sq, Hq, Dh), 0, 2, 1, 3)
        k = (lambda x, n, axis: torch.repeat_interleave(x, n, dim=axis))(k_cache[:, :, Sk - W:, :], rep, axis=1)
        v = (lambda x, n, axis: torch.repeat_interleave(x, n, dim=axis))(v_cache[:, :, Sk - W:, :], rep, axis=1)
        scores = torch.einsum("bhqd,bhkd->bhqk", q, k) * (Dh ** -0.5)
        p = _softmax(scores, axis=-1)
        o = torch.einsum("bhqk,bhkd->bhqd", p, v)
        return (lambda x, *d: x.permute(*d))(o, 0, 2, 1, 3).reshape(B, Sq, Hq * Dh) @ wo

    def _B_ref(x, w1, b1, w2, b2):
        y = _layernorm(x, axis=-1)
        h = _gelu(torch.einsum("bsd,df->bsf", y, w1) + b1)
        return torch.einsum("bsf,fd->bsd", h, w2) + b2

    x = A_x
    h = x + _A_ref(_layernorm(x, axis=-1), A_k_cache, A_v_cache, A_wq, A_wo)
    h2 = h + _B_ref(_layernorm(h, axis=-1), B_w1, B_b1, B_w2, B_b2)
    return h2
```

```asm
; @launch grid=(256,1,1) block=(576,1,1) lds=159232
.amdgcn_target "amdgcn-amd-amdhsa--gfx950"
.text
.globl sequential_preLN__sliding_block_cached__mixer_channel_mlp__decode_kernel
.p2align 8
.type sequential_preLN__sliding_block_cached__mixer_channel_mlp__decode_kernel,@function
sequential_preLN__sliding_block_cached__mixer_channel_mlp__decode_kernel:
    s_cmpk_ge_u32 s2, 256
    s_cbranch_scc1 L_end
    s_load_dwordx8 s[4:11], s[0:1], 0
    v_readfirstlane_b32 s3, v0
    s_getpc_b64 s[34:35]
L_pc:
    v_mul_u32_u24 v2, 33, v0
    global_load_ubyte v167, v2, s[34:35]
    v_and_b32 v0, 63, v0
    s_lshr_b32 s3, s3, 6
    s_and_b32 s30, s2, 7
    s_lshr_b32 s31, s2, 3
    s_and_b32 s34, s31, 1
    s_lshl1_add_u32 s30, s30, s34
    s_lshr_b32 s31, s31, 1
    s_lshr_b32 s32, s31, 1
    s_and_b32 s31, s31, 1
    v_lshrrev_b32 v5, 4, v0
    s_sub_u32 s33, s3, 1
    s_lshl4_add_u32 s59, s31, s30
    s_lshl3_add_u32 s59, s59, 7
    s_lshl_b32 s59, s59, 20
    v_lshlrev_b32 v2, 4, v0
    v_lshlrev_b32 v1, 6, v5
    v_xor_b32 v1, v1, v2
    s_mov_b32 s57, s33
    s_mulk_i32 s57, 8320
    s_addk_i32 s57, 8704
    s_cmp_eq_u32 s3, 0
    s_cbranch_scc1 L_xload
    s_lshl1_add_u32 s34, s31, s34
    s_and_b32 s35, s32, 1
    s_lshl1_add_u32 s34, s34, s35
    s_lshr_b32 s60, s33, 2
    s_lshl1_add_u32 s60, s32, s60
    s_andn2_b32 s35, s60, 3
    s_add_u32 s60, s60, s35
    s_lshl3_add_u32 s60, s60, s34
    s_and_b32 s34, s33, 3
    s_lshl2_add_u32 s60, s60, s34
    s_lshl_b32 s60, s60, 10
    s_add_u32 s34, s59, s60
    v_add_u32 v8, s34, v1
    s_mov_b32 m0, s57
    v_xor_b32 v9, 4096, v8
    s_waitcnt lgkmcnt(0)
    global_load_lds_dwordx4 v8, s[6:7] nt
    s_addk_i32 m0, 1040
    s_nop 0
    global_load_lds_dwordx4 v9, s[6:7] nt
    s_branch L_first
L_xload:
    v_mul_u32_u24 v1, 36, v0
    s_waitcnt lgkmcnt(0)
    global_load_dwordx4 v[12:15], v1, s[4:5]
    global_load_dwordx4 v[16:19], v1, s[4:5] offset:16
    global_load_dword v20, v1, s[4:5] offset:32
L_first:
    s_load_dwordx16 s[12:27], s[0:1], 32
    s_load_dwordx2 s[28:29], s[0:1], 96
    v_and_b32 v6, 15, v0
    s_lshl3_add_u32 s67, s31, s32
    s_lshr_b32 s64, s2, 3
    s_add_u32 s64, s64, 2
    s_and_b32 s65, s64, 3
    s_bfe_u32 s64, s64, 0x30002
    s_and_b32 s34, s2, 7
    s_lshl3_add_u32 s64, s34, s64
    s_mul_i32 s66, s65, 9
    s_add_u32 s66, s66, s3
    s_lshl_b32 s66, s66, 10
    s_add_u32 s66, s66, s64
    s_lshl_b32 s66, s66, 7
    v_and_b32 v3, 7, v0
    v_lshlrev_b32 v4, 1, v5
    v_xor_b32 v3, v3, v4
    v_lshlrev_b32 v120, 4, v3
    v_lshrrev_b32 v4, 3, v0
    v_lshl_add_u32 v3, v4, 13, v120
    v_add_u32 v3, s66, v3
    v_add_u32 v4, 65536, v3
    s_lshl_b32 s58, s3, 11
    s_add_u32 m0, s58, 140800
    s_nop 0
    global_load_lds_dwordx4 v3, s[10:11] nt
    s_addk_i32 m0, 1024
    s_nop 0
    global_load_lds_dwordx4 v4, s[10:11] nt
    s_and_b32 s61, s2, 7
    s_lshr_b32 s62, s2, 3
    s_cmpk_lt_u32 s2, 112
    s_cbranch_scc1 L_ids
    s_mul_i32 s34, s61, 18
    s_add_u32 s62, s62, s34
    s_sub_u32 s62, s62, 14
    s_sub_u32 s61, s2, 112
L_ids:
    v_mov_b32 v4, 0
    s_mov_b32 s47, 0x20000
    s_mov_b32 s39, 0x20000
    s_cmp_eq_u32 s3, 0
    s_cbranch_scc1 L_helper
    s_add_u32 s36, s6, s59
    s_addc_u32 s37, s7, 0
    s_and_b32 s37, s37, 0xffff
    s_mov_b32 s38, 0x100000
    s_add_u32 s40, s8, s59
    s_addc_u32 s41, s9, 0
    s_and_b32 s41, s41, 0xffff
    s_mov_b32 s42, 0x100000
    s_mov_b32 s43, 0x20000
    v_and_b32 v152, 3, v0
    v_mul_u32_u24 v152, 1040, v152
    v_lshl_add_u32 v152, v5, 4, v152
    v_add_u32 v152, s57, v152
    v_lshrrev_b32 v156, 2, v6
    v_lshl_add_u32 v152, v156, 8, v152
    v_xor_b32 v157, 3, v156
    v_lshl_add_u32 v155, v157, 6, v152
    v_xor_b32 v157, 2, v156
    v_lshl_add_u32 v154, v157, 6, v152
    v_xor_b32 v157, 1, v156
    v_lshl_add_u32 v153, v157, 6, v152
    v_xor_b32 v157, 0, v156
    v_lshl_add_u32 v152, v157, 6, v152
    s_mov_b32 s64, 0x30003
    s_mov_b32 s65, s64
    s_mov_b32 s66, 0xc000c
    s_mov_b32 s67, s66
    s_mov_b32 s68, 0x300030
    s_mov_b32 s69, s68
    s_mov_b32 s70, 0xc000c0
    s_mov_b32 s71, s70
    s_mov_b32 s72, 0x3000300
    s_mov_b32 s73, s72
    s_mov_b32 s74, 0xc000c00
    s_mov_b32 s75, s74
    s_mov_b32 s76, 0x30003000
    s_mov_b32 s77, s76
    s_mov_b32 s78, 0xc000c000
    s_mov_b32 s79, s78
    v_and_b32 v7, 1, v0
    v_lshlrev_b32 v7, 8, v7
    v_lshl_add_u32 v7, v5, 4, v7
    v_mov_b32 v121, 1
    s_waitcnt lgkmcnt(0)
    s_barrier
    s_cmpk_ge_u32 s2, 112
    s_cbranch_scc1 L_stream_m
    s_cmpk_ge_u32 s2, 72
    s_cbranch_scc1 L_stream_n
L_stream_w:
    s_lshl3_add_u32 s34, s61, s33
    s_mul_i32 s34, s34, 73728
    s_lshl_b32 s35, s62, 7
    s_add_u32 s34, s34, s35
    s_add_u32 s44, s12, s34
    s_addc_u32 s45, s13, 0
    s_and_b32 s45, s45, 0xffff
    s_mov_b32 s46, 72704
    v_and_b32 v3, 24, v0
    v_lshrrev_b32 v122, 5, v0
    v_lshl_add_u32 v3, v122, 1, v3
    v_mul_u32_u24 v3, 1152, v3
    v_add_u32 v3, v3, v120
    s_lshl_b32 s58, s33, 13
    s_add_u32 s58, s58, 75264
    v_mul_u32_u24 v122, 1152, v122
    v_and_b32 v123, 31, v0
    v_lshl_add_u32 v122, v123, 2, v122
    v_add_u32 v122, s35, v122
    s_waitcnt vmcnt(3)
    s_add_u32 m0, s57, 2080
    s_xor_b32 s83, s60, 8192
    buffer_load_dwordx4 v1, s[36:39], s83 offen nt lds
    s_waitcnt vmcnt(3)
    s_add_u32 m0, s57, 3120
    s_xor_b32 s83, s60, 12288
    buffer_load_dwordx4 v1, s[36:39], s83 offen nt lds
    global_load_dword v123, v122, s[4:5]
    s_add_u32 m0, s57, 4160
    s_xor_b32 s83, s60, 16384
    buffer_load_dwordx4 v1, s[36:39], s83 offen nt lds
    s_waitcnt vmcnt(5)
    s_add_u32 m0, s57, 5200
    s_xor_b32 s83, s60, 20480
    buffer_load_dwordx4 v1, s[36:39], s83 offen nt lds
    s_waitcnt vmcnt(5)
    s_add_u32 m0, s57, 6240
    s_xor_b32 s83, s60, 24576
    buffer_load_dwordx4 v1, s[36:39], s83 offen nt lds
    s_mov_b64 exec, 1
    ds_add_u32 v4, v121 offset:64
    s_mov_b64 exec, -1
    s_waitcnt vmcnt(5)
    s_add_u32 m0, s57, 7280
    s_xor_b32 s83, s60, 28672
    buffer_load_dwordx4 v1, s[36:39], s83 offen nt lds
    s_waitcnt vmcnt(5)
    ds_read_b128 v[8:11], v152 offset:0
    ds_read_b128 v[12:15], v153 offset:0
    ds_read_b128 v[16:19], v154 offset:0
    ds_read_b128 v[20:23], v155 offset:0
    s_waitcnt lgkmcnt(0)
    s_add_u32 m0, s57, 0
    s_xor_b32 s83, s60, 131072
    buffer_load_dwordx4 v1, s[36:39], s83 offen nt lds
    s_waitcnt vmcnt(5)
    s_add_u32 m0, s57, 1040
    s_xor_b32 s83, s60, 135168
    buffer_load_dwordx4 v1, s[36:39], s83 offen nt lds
    s_waitcnt vmcnt(4)
    s_add_u32 m0, s57, 2080
    s_xor_b32 s83, s60, 139264
    buffer_load_dwordx4 v1, s[36:39], s83 offen nt lds
    s_waitcnt vmcnt(4)
    s_add_u32 m0, s57, 3120
    s_xor_b32 s83, s60, 143360
    buffer_load_dwordx4 v1, s[36:39], s83 offen nt lds
    s_waitcnt vmcnt(4)
    ds_read_b128 v[24:27], v152 offset:4160
    ds_read_b128 v[28:31], v153 offset:4160
    ds_read_b128 v[32:35], v154 offset:4160
    ds_read_b128 v[36:39], v155 offset:4160
    s_waitcnt lgkmcnt(0)
    s_add_u32 m0, s57, 4160
    s_xor_b32 s83, s60, 147456
    buffer_load_dwordx4 v1, s[36:39], s83 offen nt lds
    s_waitcnt vmcnt(4)
    s_add_u32 m0, s57, 5200
    s_xor_b32 s83, s60, 151552
    buffer_load_dwordx4 v1, s[36:39], s83 offen nt lds
    s_waitcnt vmcnt(4)
    s_add_u32 m0, s57, 6240
    s_xor_b32 s83, s60, 155648
    buffer_load_dwordx4 v1, s[36:39], s83 offen nt lds
    s_waitcnt vmcnt(4)
    s_add_u32 m0, s57, 7280
    s_xor_b32 s83, s60, 159744
    buffer_load_dwordx4 v1, s[36:39], s83 offen nt lds
    s_waitcnt vmcnt(4)
    s_add_u32 m0, s58, 0
    s_mov_b32 s83, 0
    buffer_load_dwordx4 v3, s[44:47], s83 offen nt lds
    ds_read_b128 v[40:43], v152 offset:0
    ds_read_b128 v[44:47], v153 offset:0
    ds_read_b128 v[48:51], v154 offset:0
    ds_read_b128 v[52:55], v155 offset:0
    s_waitcnt vmcnt(4)
    s_add_u32 m0, s58, 1024
    s_mov_b32 s83, 4608
    buffer_load_dwordx4 v3, s[44:47], s83 offen nt lds
    s_waitcnt vmcnt(4)
    s_add_u32 m0, s58, 2048
    s_mov_b32 s83, 1152
    buffer_load_dwordx4 v3, s[44:47], s83 offen nt lds
    s_waitcnt vmcnt(4)
    s_xor_b32 s83, s60, 0
    buffer_load_dwordx4 v[72:75], v2, s[40:43], s83 offen nt
    s_waitcnt vmcnt(4)
    s_add_u32 m0, s58, 3072
    s_mov_b32 s83, 5760
    buffer_load_dwordx4 v3, s[44:47], s83 offen nt lds
    ds_read_b128 v[56:59], v152 offset:4160
    ds_read_b128 v[60:63], v153 offset:4160
    ds_read_b128 v[64:67], v154 offset:4160
    ds_read_b128 v[68:71], v155 offset:4160
    s_waitcnt vmcnt(4)
    s_add_u32 m0, s58, 4096
    s_mov_b32 s83, 36864
    buffer_load_dwordx4 v3, s[44:47], s83 offen nt lds
    s_waitcnt vmcnt(4)
    s_xor_b32 s83, s60, 4096
    buffer_load_dwordx4 v[76:79], v2, s[40:43], s83 offen nt
    s_waitcnt vmcnt(4)
    s_xor_b32 s83, s60, 8192
    buffer_load_dwordx4 v[80:83], v2, s[40:43], s83 offen nt
    s_waitcnt vmcnt(4)
    s_xor_b32 s83, s60, 12288
    buffer_load_dwordx4 v[84:87], v2, s[40:43], s83 offen nt
    s_mov_b32 s82, 0
L_sqw:
    ds_read_b32 v152, v4 offset:68
    s_add_u32 s82, s82, 1
    s_cmp_gt_u32 s82, 4194304
    s_cbranch_scc1 L_sqw_done
    s_waitcnt lgkmcnt(0)
    v_cmp_eq_u32 vcc, 1, v152
    s_cbranch_vccnz L_sqw_done
    s_sleep 1
    s_branch L_sqw
L_sqw_done:
    ds_read_b128 v[136:139], v7 offset:1536
    ds_read_b128 v[140:143], v7 offset:1600
    ds_read_b128 v[144:147], v7 offset:1664
    ds_read_b128 v[148:151], v7 offset:1728
    s_waitcnt lgkmcnt(0)
    v_mfma_f32_16x16x32_bf16 v[152:155], v[8:11], v[136:139], 0
    v_mfma_f32_16x16x32_bf16 v[156:159], v[24:27], v[136:139], 0
    v_mfma_f32_16x16x32_bf16 v[160:163], v[40:43], v[136:139], 0
    v_mfma_f32_16x16x32_bf16 v[164:167], v[56:59], v[136:139], 0
    v_mfma_f32_16x16x32_bf16 v[152:155], v[12:15], v[140:143], v[152:155]
    v_mfma_f32_16x16x32_bf16 v[156:159], v[28:31], v[140:143], v[156:159]
    v_mfma_f32_16x16x32_bf16 v[160:163], v[44:47], v[140:143], v[160:163]
    v_mfma_f32_16x16x32_bf16 v[164:167], v[60:63], v[140:143], v[164:167]
    v_mfma_f32_16x16x32_bf16 v[152:155], v[16:19], v[144:147], v[152:155]
    v_mfma_f32_16x16x32_bf16 v[156:159], v[32:35], v[144:147], v[156:159]
    v_mfma_f32_16x16x32_bf16 v[160:163], v[48:51], v[144:147], v[160:163]
    v_mfma_f32_16x16x32_bf16 v[164:167], v[64:67], v[144:147], v[164:167]
    v_mfma_f32_16x16x32_bf16 v[152:155], v[20:23], v[148:151], v[152:155]
    v_mfma_f32_16x16x32_bf16 v[156:159], v[36:39], v[148:151], v[156:159]
    v_mfma_f32_16x16x32_bf16 v[160:163], v[52:55], v[148:151], v[160:163]
    v_mfma_f32_16x16x32_bf16 v[164:167], v[68:71], v[148:151], v[164:167]
    s_waitcnt vmcnt(4)
    s_xor_b32 s83, s60, 16384
    buffer_load_dwordx4 v[88:91], v2, s[40:43], s83 offen nt
    s_mov_b32 s34, 0x3db504f3
    s_lshl_b32 s35, s33, 3
    v_lshl_add_u32 v7, v0, 6, s35
    v_cvt_pk_bf16_f32 v152, 0, v152
    v_cvt_pk_bf16_f32 v153, 0, v153
    v_cvt_pk_bf16_f32 v154, 0, v154
    v_cvt_pk_bf16_f32 v155, 0, v155
    v_cvt_pk_bf16_f32 v156, 0, v156
    v_cvt_pk_bf16_f32 v157, 0, v157
    v_cvt_pk_bf16_f32 v158, 0, v158
    v_cvt_pk_bf16_f32 v159, 0, v159
    v_cvt_pk_bf16_f32 v160, 0, v160
    v_cvt_pk_bf16_f32 v161, 0, v161
    v_cvt_pk_bf16_f32 v162, 0, v162
    v_cvt_pk_bf16_f32 v163, 0, v163
    v_cvt_pk_bf16_f32 v164, 0, v164
    v_cvt_pk_bf16_f32 v165, 0, v165
    v_cvt_pk_bf16_f32 v166, 0, v166
    v_cvt_pk_bf16_f32 v167, 0, v167
    v_mul_f32 v152, s34, v152
    v_mul_f32 v153, s34, v153
    v_mul_f32 v154, s34, v154
    v_mul_f32 v155, s34, v155
    v_mul_f32 v156, s34, v156
    v_mul_f32 v157, s34, v157
    v_mul_f32 v158, s34, v158
    v_mul_f32 v159, s34, v159
    v_mul_f32 v160, s34, v160
    v_mul_f32 v161, s34, v161
    v_mul_f32 v162, s34, v162
    v_mul_f32 v163, s34, v163
    v_mul_f32 v164, s34, v164
    v_mul_f32 v165, s34, v165
    v_mul_f32 v166, s34, v166
    v_mul_f32 v167, s34, v167
    v_cvt_pk_bf16_f32 v152, 0, v152
    v_cvt_pk_bf16_f32 v153, 0, v153
    v_cvt_pk_bf16_f32 v154, 0, v154
    v_cvt_pk_bf16_f32 v155, 0, v155
    v_cvt_pk_bf16_f32 v156, 0, v156
    v_cvt_pk_bf16_f32 v157, 0, v157
    v_cvt_pk_bf16_f32 v158, 0, v158
    v_cvt_pk_bf16_f32 v159, 0, v159
    v_cvt_pk_bf16_f32 v160, 0, v160
    v_cvt_pk_bf16_f32 v161, 0, v161
    v_cvt_pk_bf16_f32 v162, 0, v162
    v_cvt_pk_bf16_f32 v163, 0, v163
    v_cvt_pk_bf16_f32 v164, 0, v164
    v_cvt_pk_bf16_f32 v165, 0, v165
    v_cvt_pk_bf16_f32 v166, 0, v166
    v_cvt_pk_bf16_f32 v167, 0, v167
    v_max3_f32 v148, v152, v153, v154
    v_max3_f32 v148, v148, v155, v156
    v_max3_f32 v148, v148, v157, v158
    v_max3_f32 v148, v148, v159, v160
    v_max3_f32 v148, v148, v161, v162
    v_max3_f32 v148, v148, v163, v164
    v_max3_f32 v148, v148, v165, v166
    v_max_f32 v148, v148, v167
    v_mov_b32 v149, v148
    s_nop 1
    v_permlane16_swap_b32 v148, v149
    v_max_f32 v148, v148, v149
    v_mov_b32 v149, v148
    s_nop 1
    v_permlane32_swap_b32 v148, v149
    v_max_f32 v148, v148, v149
    s_waitcnt vmcnt(4)
    s_xor_b32 s83, s60, 20480
    buffer_load_dwordx4 v[92:95], v2, s[40:43], s83 offen nt
    s_mov_b32 s34, 0x3fb8aa3b
    v_sub_f32 v152, v152, v148
    v_sub_f32 v153, v153, v148
    v_sub_f32 v154, v154, v148
    v_sub_f32 v155, v155, v148
    v_sub_f32 v156, v156, v148
    v_sub_f32 v157, v157, v148
    v_sub_f32 v158, v158, v148
    v_sub_f32 v159, v159, v148
    v_sub_f32 v160, v160, v148
    v_sub_f32 v161, v161, v148
    v_sub_f32 v162, v162, v148
    v_sub_f32 v163, v163, v148
    v_sub_f32 v164, v164, v148
    v_sub_f32 v165, v165, v148
    v_sub_f32 v166, v166, v148
    v_sub_f32 v167, v167, v148
    v_mul_f32 v152, s34, v152
    v_mul_f32 v153, s34, v153
    v_mul_f32 v154, s34, v154
    v_mul_f32 v155, s34, v155
    v_mul_f32 v156, s34, v156
    v_mul_f32 v157, s34, v157
    v_mul_f32 v158, s34, v158
    v_mul_f32 v159, s34, v159
    v_mul_f32 v160, s34, v160
    v_mul_f32 v161, s34, v161
    v_mul_f32 v162, s34, v162
    v_mul_f32 v163, s34, v163
    v_mul_f32 v164, s34, v164
    v_mul_f32 v165, s34, v165
    v_mul_f32 v166, s34, v166
    v_mul_f32 v167, s34, v167
    v_exp_f32 v152, v152
    v_exp_f32 v153, v153
    v_exp_f32 v154, v154
    v_exp_f32 v155, v155
    v_exp_f32 v156, v156
    v_exp_f32 v157, v157
    v_exp_f32 v158, v158
    v_exp_f32 v159, v159
    v_exp_f32 v160, v160
    v_exp_f32 v161, v161
    v_exp_f32 v162, v162
    v_exp_f32 v163, v163
    v_exp_f32 v164, v164
    v_exp_f32 v165, v165
    v_exp_f32 v166, v166
    v_exp_f32 v167, v167
    v_cvt_pk_bf16_f32 v56, v152, v152
    v_cvt_pk_bf16_f32 v57, v153, v153
    v_cvt_pk_bf16_f32 v58, v154, v154
    v_cvt_pk_bf16_f32 v59, v155, v155
    v_cvt_pk_bf16_f32 v60, v156, v156
    v_cvt_pk_bf16_f32 v61, v157, v157
    v_cvt_pk_bf16_f32 v62, v158, v158
    v_cvt_pk_bf16_f32 v63, v159, v159
    v_cvt_pk_bf16_f32 v64, v160, v160
    v_cvt_pk_bf16_f32 v65, v161, v161
    v_cvt_pk_bf16_f32 v66, v162, v162
    v_cvt_pk_bf16_f32 v67, v163, v163
    v_cvt_pk_bf16_f32 v68, v164, v164
    v_cvt_pk_bf16_f32 v69, v165, v165
    v_cvt_pk_bf16_f32 v70, v166, v166
    v_cvt_pk_bf16_f32 v71, v167, v167
    v_add_f32 v152, v152, v160
    v_add_f32 v153, v153, v161
    v_add_f32 v154, v154, v162
    v_add_f32 v155, v155, v163
    v_add_f32 v156, v156, v164
    v_add_f32 v157, v157, v165
    v_add_f32 v158, v158, v166
    v_add_f32 v159, v159, v167
    v_add_f32 v152, v152, v156
    v_add_f32 v153, v153, v157
    v_add_f32 v154, v154, v158
    v_add_f32 v155, v155, v159
    v_add_f32 v152, v152, v154
    v_add_f32 v153, v153, v155
    v_add_f32 v149, v152, v153
    v_mov_b32 v150, v149
    s_nop 1
    v_permlane16_swap_b32 v149, v150
    v_add_f32 v149, v149, v150
    v_mov_b32 v150, v149
    s_nop 1
    v_permlane32_swap_b32 v149, v150
    v_add_f32 v149, v149, v150
    v_mov_b32 v150, 1
    s_mov_b64 exec, 3
    ds_write_b64 v7, v[148:149] offset:384
    s_mov_b64 exec, 1
    ds_add_u32 v4, v150 offset:72
    s_mov_b64 exec, -1
    s_waitcnt vmcnt(4)
    s_xor_b32 s83, s60, 24576
    buffer_load_dwordx4 v[96:99], v2, s[40:43], s83 offen nt
    v_add_u32 v7, s57, v2
    v_add_u32 v148, 8704, v2
    s_lshl3_add_u32 s35, s31, s32
    s_lshl_b32 s34, s30, 5
    s_add_u32 s34, s34, s35
    s_lshl_b32 s34, s34, 8
    s_add_u32 s34, s34, 139264
    v_and_b32 v157, 1, v0
    v_lshlrev_b32 v161, 12, v157
    v_lshrrev_b32 v158, 1, v0
    v_lshl_add_u32 v149, v158, 3, v161
    v_add_u32 v149, s34, v149
    s_lshl_b32 s34, s30, 13
    s_lshl4_add_u32 s34, s35, s34
    s_add_u32 s34, s34, 270336
    v_lshrrev_b32 v158, 2, v0
    v_lshl_add_u32 v161, v158, 8, v161
    v_and_b32 v158, 2, v0
    v_lshl_add_u32 v161, v158, 2, v161
    v_add_u32 v161, s34, v161
    s_lshl_b32 s34, s33, 2
    v_lshl_add_u32 v157, v157, 5, s34
    v_mov_b32 v140, 0xffff
    v_mov_b32 v141, 0xffff0000
    v_cndmask_b32_e64 v136, 0, v140, s[64:65]
    v_cndmask_b32_e64 v136, v136, v141, s[66:67]
    v_cndmask_b32_e64 v137, 0, v140, s[68:69]
    v_cndmask_b32_e64 v137, v137, v141, s[70:71]
    v_cndmask_b32_e64 v138, 0, v140, s[72:73]
    v_cndmask_b32_e64 v138, v138, v141, s[74:75]
    v_cndmask_b32_e64 v139, 0, v140, s[76:77]
    v_cndmask_b32_e64 v139, v139, v141, s[78:79]
    v_and_b32 v40, v136, v56
    v_and_b32 v41, v137, v56
    v_and_b32 v42, v138, v56
    v_and_b32 v43, v139, v56
    s_nop 1
    v_mfma_f32_16x16x32_bf16 v[144:147], v[72:75], v[40:43], 0
    v_and_b32 v44, v136, v57
    v_and_b32 v45, v137, v57
    v_and_b32 v46, v138, v57
    v_and_b32 v47, v139, v57
    s_nop 1
    v_mfma_f32_16x16x32_bf16 v[144:147], v[76:79], v[44:47], v[144:147]
    v_and_b32 v48, v136, v58
    v_and_b32 v49, v137, v58
    v_and_b32 v50, v138, v58
    v_and_b32 v51, v139, v58
    s_waitcnt vmcnt(4)
    s_xor_b32 s83, s60, 28672
    buffer_load_dwordx4 v[100:103], v2, s[40:43], s83 offen nt
    v_mfma_f32_16x16x32_bf16 v[144:147], v[80:83], v[48:51], v[144:147]
    v_and_b32 v52, v136, v59
    v_and_b32 v53, v137, v59
    v_and_b32 v54, v138, v59
    v_and_b32 v55, v139, v59
    s_waitcnt vmcnt(4)
    s_xor_b32 s83, s60, 131072
    buffer_load_dwordx4 v[104:107], v2, s[40:43], s83 offen nt
    v_mfma_f32_16x16x32_bf16 v[144:147], v[84:87], v[52:55], v[144:147]
    v_and_b32 v40, v136, v60
    v_and_b32 v41, v137, v60
    v_and_b32 v42, v138, v60
    v_and_b32 v43, v139, v60
    s_waitcnt vmcnt(4)
    s_xor_b32 s83, s60, 135168
    buffer_load_dwordx4 v[108:111], v2, s[40:43], s83 offen nt
    v_mfma_f32_16x16x32_bf16 v[144:147], v[88:91], v[40:43], v[144:147]
    v_and_b32 v44, v136, v61
    v_and_b32 v45, v137, v61
    v_and_b32 v46, v138, v61
    v_and_b32 v47, v139, v61
    s_waitcnt vmcnt(4)
    s_xor_b32 s83, s60, 139264
    buffer_load_dwordx4 v[112:115], v2, s[40:43], s83 offen nt
    v_mfma_f32_16x16x32_bf16 v[144:147], v[92:95], v[44:47], v[144:147]
    v_and_b32 v48, v136, v62
    v_and_b32 v49, v137, v62
    v_and_b32 v50, v138, v62
    v_and_b32 v51, v139, v62
    s_waitcnt vmcnt(4)
    s_xor_b32 s83, s60, 143360
    buffer_load_dwordx4 v[116:119], v2, s[40:43], s83 offen nt
    v_mfma_f32_16x16x32_bf16 v[144:147], v[96:99], v[48:51], v[144:147]
    v_and_b32 v52, v136, v63
    v_and_b32 v53, v137, v63
    v_and_b32 v54, v138, v63
    v_and_b32 v55, v139, v63
    s_waitcnt vmcnt(4)
    s_xor_b32 s83, s60, 147456
    buffer_load_dwordx4 v[24:27], v2, s[40:43], s83 offen nt
    v_mfma_f32_16x16x32_bf16 v[144:147], v[100:103], v[52:55], v[144:147]
    s_cmp_eq_u32 s33, 0
    s_cbranch_scc0 L_noprg
    ds_write_b32 v4, v150 offset:100
L_noprg:
    v_and_b32 v40, v136, v64
    v_and_b32 v41, v137, v64
    v_and_b32 v42, v138, v64
    v_and_b32 v43, v139, v64
    s_waitcnt vmcnt(4)
    s_xor_b32 s83, s60, 151552
    buffer_load_dwordx4 v[28:31], v2, s[40:43], s83 offen nt
    v_mfma_f32_16x16x32_bf16 v[144:147], v[104:107], v[40:43], v[144:147]
    v_and_b32 v44, v136, v65
    v_and_b32 v45, v137, v65
    v_and_b32 v46, v138, v65
    v_and_b32 v47, v139, v65
    s_waitcnt vmcnt(4)
    s_xor_b32 s83, s60, 155648
    buffer_load_dwordx4 v[32:35], v2, s[40:43], s83 offen nt
    v_mfma_f32_16x16x32_bf16 v[144:147], v[108:111], v[44:47], v[144:147]
    v_lshrrev_b32 v92, 2, v0
    v_lshlrev_b32 v72, 7, v92
    v_bfe_u32 v92, v0, 3, 2
    v_lshl_add_u32 v72, v92, 5, v72
    v_and_b32 v92, 3, v0
    v_lshl_add_u32 v72, v92, 3, v72
    v_add_u32 v72, s58, v72
    v_xor_b32 v73, 32, v72
    v_xor_b32 v74, 64, v72
    v_xor_b32 v75, 96, v72
    s_lshr_b32 s35, s33, 1
    s_lshl2_add_u32 s34, s61, s35
    s_lshl_b32 s34, s34, 12
    s_lshl_b32 s35, s35, 6
    v_lshl_add_u32 v81, v5, 4, s35
    s_and_b32 s35, s33, 1
    s_lshl_b32 s35, s35, 7
    s_add_u32 s34, s34, s35
    s_add_u32 s34, s34, 139264
    v_lshlrev_b32 v76, 8, v6
    v_lshl_add_u32 v76, v5, 4, v76
    v_add_u32 v76, s34, v76
    v_add_u32 v91, 64, v76
    s_lshl3_add_u32 s34, s61, s33
    s_lshl_b32 s34, s34, 11
    s_add_u32 s34, s34, 270336
    v_add_u32 v93, s34, v2
    v_add_u32 v94, 1024, v93
    s_lshl_b32 s34, s33, 9
    s_add_u32 s34, s34, 4352
    v_and_b32 v77, 32, v0
    v_add_u32 v77, v77, v0
    v_lshl_add_u32 v77, v77, 2, s34
    v_lshlrev_b32 v78, 3, v0
    s_andn2_b32 s34, s62, 3
    s_add_u32 s34, s34, s62
    s_lshl3_add_u32 s34, s34, s61
    s_lshl_b32 s34, s34, 8
    s_add_u32 s34, s34, 458752
    v_lshl_add_u32 v79, v0, 2, s34
    v_add_u32 v84, 8192, v79
    s_andn2_b32 s34, s62, 3
    s_add_u32 s34, s34, s62
    s_lshl_b32 s34, s34, 11
    s_lshl2_add_u32 s34, s61, s34
    s_add_u32 s34, s34, 409600
    v_lshl_add_u32 v80, v6, 7, s34
    v_bfe_u32 v92, v0, 2, 1
    v_xor_b32 v92, 0, v92
    v_lshl_add_u32 v80, v92, 13, v80
    s_cmp_eq_u32 s61, 0
    s_cselect_b32 s34, -1, 0
    v_and_b32 v82, s34, v123
    v_and_b32 v83, 0xffff0000, v82
    v_lshlrev_b32 v82, 16, v82
    v_and_b32 v48, v136, v66
    v_and_b32 v49, v137, v66
    v_and_b32 v50, v138, v66
    v_and_b32 v51, v139, v66
    s_waitcnt vmcnt(4)
    s_xor_b32 s83, s60, 159744
    buffer_load_dwordx4 v[36:39], v2, s[40:43], s83 offen nt
    v_mfma_f32_16x16x32_bf16 v[144:147], v[112:115], v[48:51], v[144:147]
    v_and_b32 v52, v136, v67
    v_and_b32 v53, v137, v67
    v_and_b32 v54, v138, v67
    v_and_b32 v55, v139, v67
    s_waitcnt vmcnt(4)
    s_add_u32 m0, s58, 5120
    s_mov_b32 s83, 41472
    buffer_load_dwordx4 v3, s[44:47], s83 offen nt lds
    v_mfma_f32_16x16x32_bf16 v[144:147], v[116:119], v[52:55], v[144:147]
    v_and_b32 v40, v136, v68
    v_and_b32 v41, v137, v68
    v_and_b32 v42, v138, v68
    v_and_b32 v43, v139, v68
    s_waitcnt vmcnt(4)
    s_add_u32 m0, s58, 6144
    s_mov_b32 s83, 38016
    buffer_load_dwordx4 v3, s[44:47], s83 offen nt lds
    v_mfma_f32_16x16x32_bf16 v[144:147], v[24:27], v[40:43], v[144:147]
    v_and_b32 v44, v136, v69
    v_and_b32 v45, v137, v69
    v_and_b32 v46, v138, v69
    v_and_b32 v47, v139, v69
    s_waitcnt vmcnt(4)
    s_add_u32 m0, s58, 7168
    s_mov_b32 s83, 42624
    buffer_load_dwordx4 v3, s[44:47], s83 offen nt lds
    v_mfma_f32_16x16x32_bf16 v[144:147], v[28:31], v[44:47], v[144:147]
    v_and_b32 v48, v136, v70
    v_and_b32 v49, v137, v70
    v_and_b32 v50, v138, v70
    v_and_b32 v51, v139, v70
    s_mov_b32 s82, 0
L_sfw:
    ds_read_b32 v158, v4 offset:80
    s_add_u32 s82, s82, 1
    s_cmp_gt_u32 s82, 4194304
    s_cbranch_scc1 L_sfw_done
    s_waitcnt lgkmcnt(0)
    v_cmp_ne_u32 vcc, 0, v158
    s_cbranch_vccnz L_sfw_done
    s_sleep 1
    s_branch L_sfw
L_sfw_done:
    v_readfirstlane_b32 s54, v158
    ds_read_b32 v158, v157 offset:128
    ds_read_b32 v160, v4 offset:76
    s_waitcnt vmcnt(4)
    v_mfma_f32_16x16x32_bf16 v[144:147], v[32:35], v[48:51], v[144:147]
    v_and_b32 v52, v136, v71
    v_and_b32 v53, v137, v71
    v_and_b32 v54, v138, v71
    v_and_b32 v55, v139, v71
    s_waitcnt lgkmcnt(0)
    s_waitcnt vmcnt(3)
    v_mfma_f32_16x16x32_bf16 v[144:147], v[36:39], v[52:55], v[144:147]
    ds_read2_b32 v[152:153], v4 offset0:26 offset1:21
    s_nop 6
    v_pk_mul_f32 v[144:145], v[144:145], v[158:159] op_sel_hi:[1,0]
    v_pk_mul_f32 v[146:147], v[146:147], v[158:159] op_sel_hi:[1,0]
    ds_write_b128 v7, v[144:147]
    s_mov_b64 exec, 1
    ds_add_rtn_u32 v159, v4, v150 offset:84
    s_mov_b64 exec, -1
    ds_read_b128 v[8:11], v148 offset:0
    ds_read_b128 v[12:15], v148 offset:8320
    ds_read_b128 v[16:19], v148 offset:16640
    ds_read_b128 v[20:23], v148 offset:24960
    ds_read_b128 v[24:27], v148 offset:33280
    ds_read_b128 v[28:31], v148 offset:41600
    ds_read_b128 v[32:35], v148 offset:49920
    ds_read_b128 v[36:39], v148 offset:58240
    s_waitcnt lgkmcnt(8)
    v_readfirstlane_b32 s34, v159
    v_readfirstlane_b32 s63, v152
    s_cmp_eq_u32 s34, 7
    s_cbranch_scc0 L_noredw
L_redw:
    s_waitcnt lgkmcnt(6)
    v_pk_add_f32 v[8:9], v[8:9], v[12:13]
    v_pk_add_f32 v[10:11], v[10:11], v[14:15]
    s_waitcnt lgkmcnt(5)
    v_pk_add_f32 v[8:9], v[8:9], v[16:17]
    v_pk_add_f32 v[10:11], v[10:11], v[18:19]
    s_waitcnt lgkmcnt(4)
    v_pk_add_f32 v[8:9], v[8:9], v[20:21]
    v_pk_add_f32 v[10:11], v[10:11], v[22:23]
    s_waitcnt lgkmcnt(3)
    v_pk_add_f32 v[8:9], v[8:9], v[24:25]
    v_pk_add_f32 v[10:11], v[10:11], v[26:27]
    s_waitcnt lgkmcnt(2)
    v_pk_add_f32 v[8:9], v[8:9], v[28:29]
    v_pk_add_f32 v[10:11], v[10:11], v[30:31]
    s_waitcnt lgkmcnt(1)
    v_pk_add_f32 v[8:9], v[8:9], v[32:33]
    v_pk_add_f32 v[10:11], v[10:11], v[34:35]
    s_waitcnt lgkmcnt(0)
    v_pk_add_f32 v[8:9], v[8:9], v[36:37]
    v_pk_add_f32 v[10:11], v[10:11], v[38:39]
    v_cvt_pk_bf16_f32 v8, v8, v9
    v_cvt_pk_bf16_f32 v9, v10, v11
    global_store_dwordx2 v161, v[8:9], s[28:29]
    s_cmp_eq_u32 s54, 2
    s_cbranch_scc1 L_noredw
    global_store_dwordx2 v149, v[8:9], s[28:29] sc1
L_noredw:
    s_cmp_eq_u32 s63, 2
    s_cbranch_scc0 L_gs
L_gsok:
    global_load_dwordx4 v[104:107], v93, s[28:29] sc1
    global_load_dwordx4 v[108:111], v94, s[28:29] sc1
    ds_read_b128 v[128:131], v81 offset:1024
    s_waitcnt vmcnt(2)
    ds_read_b64_tr_b16 v[40:41], v72 offset:0
    ds_read_b64_tr_b16 v[42:43], v72 offset:2048
    ds_read_b64_tr_b16 v[44:45], v72 offset:4096
    ds_read_b64_tr_b16 v[46:47], v72 offset:6144
    ds_read_b64_tr_b16 v[48:49], v73 offset:0
    ds_read_b64_tr_b16 v[50:51], v73 offset:2048
    ds_read_b64_tr_b16 v[52:53], v73 offset:4096
    ds_read_b64_tr_b16 v[54:55], v73 offset:6144
    ds_read_b64_tr_b16 v[56:57], v74 offset:0
    ds_read_b64_tr_b16 v[58:59], v74 offset:2048
    ds_read_b64_tr_b16 v[60:61], v74 offset:4096
    ds_read_b64_tr_b16 v[62:63], v74 offset:6144
    ds_read_b64_tr_b16 v[64:65], v75 offset:0
    ds_read_b64_tr_b16 v[66:67], v75 offset:2048
    ds_read_b64_tr_b16 v[68:69], v75 offset:4096
    ds_read_b64_tr_b16 v[70:71], v75 offset:6144
    s_mov_b32 s82, 0
    s_waitcnt lgkmcnt(0)
    s_branch L_pa_go
L_pa_retry:
    s_add_u32 s82, s82, 1
    s_cmp_gt_u32 s82, 65536
    s_cbranch_scc1 L_pa_mm
    s_mov_b64 exec, vcc
    global_load_dwordx4 v[104:107], v93, s[28:29] sc1
    global_load_dwordx4 v[108:111], v94, s[28:29] sc1
L_pa_go:
    s_waitcnt vmcnt(0)
    v_max_u32 v132, v104, v108
    v_cmp_eq_u32 vcc, -1, v132
    s_cbranch_vccnz L_pa_retry
L_pa_mm:
    s_mov_b64 exec, 1
    ds_add_u32 v4, v150 offset:92
    s_mov_b64 exec, -1
    v_mfma_f32_16x16x32_bf16 v[112:115], v[104:107], v[40:43], 0
    v_mfma_f32_16x16x32_bf16 v[112:115], v[108:111], v[44:47], v[112:115]
    v_mfma_f32_16x16x32_bf16 v[116:119], v[104:107], v[48:51], 0
    v_mfma_f32_16x16x32_bf16 v[116:119], v[108:111], v[52:55], v[116:119]
    v_mfma_f32_16x16x32_bf16 v[120:123], v[104:107], v[56:59], 0
    v_mfma_f32_16x16x32_bf16 v[120:123], v[108:111], v[60:63], v[120:123]
    v_mfma_f32_16x16x32_bf16 v[124:127], v[104:107], v[64:67], 0
    v_mfma_f32_16x16x32_bf16 v[124:127], v[108:111], v[68:71], v[124:127]
    v_max3_u32 v132, v105, v106, v107
    v_max3_u32 v132, v132, v109, v110
    v_max_u32 v132, v132, v111
    v_cmp_eq_u32 vcc, -1, v132
    v_pk_mul_f32 v[112:113], v[112:113], v[128:129]
    v_pk_fma_f32 v[112:113], v[114:115], v[130:131], v[112:113]
    v_add_f32 v134, v112, v113
    s_cbranch_vccnz L_pa_again
L_pa_done:
    v_pk_mul_f32 v[116:117], v[116:117], v[128:129]
    v_pk_fma_f32 v[116:117], v[118:119], v[130:131], v[116:117]
    v_add_f32 v135, v116, v117
    v_pk_mul_f32 v[120:121], v[120:121], v[128:129]
    v_pk_fma_f32 v[120:121], v[122:123], v[130:131], v[120:121]
    v_add_f32 v136, v120, v121
    v_permlane16_swap_b32 v134, v135
    v_pk_mul_f32 v[124:125], v[124:125], v[128:129]
    v_pk_fma_f32 v[124:125], v[126:127], v[130:131], v[124:125]
    v_add_f32 v137, v124, v125
    v_add_f32 v134, v134, v135
    s_nop 0
    v_permlane16_swap_b32 v136, v137
    v_add_f32 v136, v136, v137
    ds_write2_b32 v77, v134, v136 offset0:0 offset1:32
    s_mov_b64 exec, 1
    ds_add_rtn_u32 v159, v4, v150 offset:88
    s_mov_b64 exec, -1
    ds_read_b64 v[8:9], v78 offset:4352
    ds_read_b64 v[10:11], v78 offset:4864
    ds_read_b64 v[12:13], v78 offset:5376
    ds_read_b64 v[14:15], v78 offset:5888
    ds_read_b64 v[16:17], v78 offset:6400
    ds_read_b64 v[18:19], v78 offset:6912
    ds_read_b64 v[20:21], v78 offset:7424
    ds_read_b64 v[22:23], v78 offset:7936
    s_waitcnt lgkmcnt(8)
    v_readfirstlane_b32 s34, v159
    s_nop 0
    s_cmp_eq_u32 s34, 7
    s_cbranch_scc0 L_fin
    s_waitcnt lgkmcnt(6)
    v_pk_add_f32 v[8:9], v[8:9], v[82:83]
    s_waitcnt lgkmcnt(4)
    v_pk_add_f32 v[10:11], v[10:11], v[12:13]
    v_pk_add_f32 v[8:9], v[8:9], v[14:15]
    s_waitcnt lgkmcnt(2)
    v_pk_add_f32 v[10:11], v[10:11], v[16:17]
    v_pk_add_f32 v[8:9], v[8:9], v[18:19]
    s_waitcnt lgkmcnt(0)
    v_pk_add_f32 v[10:11], v[10:11], v[20:21]
    v_pk_add_f32 v[8:9], v[8:9], v[22:23]
    v_pk_add_f32 v[8:9], v[8:9], v[10:11]
    v_cvt_pk_bf16_f32 v8, v8, v9
    global_store_dword v79, v8, s[28:29] sc1
    global_store_dword v84, v8, s[28:29] sc1
    s_branch L_fin
L_stream_n:
    v_mul_u32_u24 v124, 7282, v0
    v_lshrrev_b32 v124, 16, v124
    v_mul_u32_u24 v125, 9, v124
    v_sub_u32 v125, v0, v125
    s_and_b32 s35, s2, 7
    s_mul_i32 s35, s35, 9
    v_add_lshl_u32 v125, v125, s35, 7
    s_lshr_b32 s34, s2, 3
    s_sub_u32 s34, s34, 9
    s_lshl3_add_u32 s34, s34, s33
    s_mul_i32 s34, s34, 8
    s_add_u32 s34, s34, 288
    v_add_u32 v124, s34, v124
    s_waitcnt vmcnt(3)
    s_add_u32 m0, s57, 2080
    s_xor_b32 s83, s60, 8192
    buffer_load_dwordx4 v1, s[36:39], s83 offen nt lds
    s_waitcnt vmcnt(3)
    s_add_u32 m0, s57, 3120
    s_xor_b32 s83, s60, 12288
    buffer_load_dwordx4 v1, s[36:39], s83 offen nt lds
    s_waitcnt vmcnt(2)
    s_add_u32 m0, s57, 4160
    s_xor_b32 s83, s60, 16384
    buffer_load_dwordx4 v1, s[36:39], s83 offen nt lds
    s_mov_b64 exec, 1
    ds_add_u32 v4, v121 offset:64
    s_mov_b64 exec, -1
    s_waitcnt vmcnt(2)
    s_add_u32 m0, s57, 5200
    s_xor_b32 s83, s60, 20480
    buffer_load_dwordx4 v1, s[36:39], s83 offen nt lds
    s_waitcnt vmcnt(2)
    s_add_u32 m0, s57, 6240
    s_xor_b32 s83, s60, 24576
    buffer_load_dwordx4 v1, s[36:39], s83 offen nt lds
    ds_read_b128 v[8:11], v152 offset:0
    ds_read_b128 v[12:15], v153 offset:0
    ds_read_b128 v[16:19], v154 offset:0
    ds_read_b128 v[20:23], v155 offset:0
    s_waitcnt vmcnt(2)
    s_add_u32 m0, s57, 7280
    s_xor_b32 s83, s60, 28672
    buffer_load_dwordx4 v1, s[36:39], s83 offen nt lds
    s_waitcnt vmcnt(2)
    s_waitcnt lgkmcnt(0)
    s_add_u32 m0, s57, 0
    s_xor_b32 s83, s60, 131072
    buffer_load_dwordx4 v1, s[36:39], s83 offen nt lds
    s_waitcnt vmcnt(2)
    s_add_u32 m0, s57, 1040
    s_xor_b32 s83, s60, 135168
    buffer_load_dwordx4 v1, s[36:39], s83 offen nt lds
    s_waitcnt vmcnt(2)
    s_add_u32 m0, s57, 2080
    s_xor_b32 s83, s60, 139264
    buffer_load_dwordx4 v1, s[36:39], s83 offen nt lds
    ds_read_b128 v[24:27], v152 offset:4160
    ds_read_b128 v[28:31], v153 offset:4160
    ds_read_b128 v[32:35], v154 offset:4160
    ds_read_b128 v[36:39], v155 offset:4160
    s_waitcnt vmcnt(2)
    s_add_u32 m0, s57, 3120
    s_xor_b32 s83, s60, 143360
    buffer_load_dwordx4 v1, s[36:39], s83 offen nt lds
    s_waitcnt vmcnt(2)
    s_waitcnt lgkmcnt(0)
    s_add_u32 m0, s57, 4160
    s_xor_b32 s83, s60, 147456
    buffer_load_dwordx4 v1, s[36:39], s83 offen nt lds
    s_waitcnt vmcnt(2)
    s_add_u32 m0, s57, 5200
    s_xor_b32 s83, s60, 151552
    buffer_load_dwordx4 v1, s[36:39], s83 offen nt lds
    s_waitcnt vmcnt(2)
    s_add_u32 m0, s57, 6240
    s_xor_b32 s83, s60, 155648
    buffer_load_dwordx4 v1, s[36:39], s83 offen nt lds
    ds_read_b128 v[40:43], v152 offset:0
    ds_read_b128 v[44:47], v153 offset:0
    ds_read_b128 v[48:51], v154 offset:0
    ds_read_b128 v[52:55], v155 offset:0
    s_waitcnt vmcnt(2)
    s_add_u32 m0, s57, 7280
    s_xor_b32 s83, s60, 159744
    buffer_load_dwordx4 v1, s[36:39], s83 offen nt lds
    s_waitcnt vmcnt(2)
    s_xor_b32 s83, s60, 0
    buffer_load_dwordx4 v[72:75], v2, s[40:43], s83 offen nt
    s_waitcnt vmcnt(2)
    s_xor_b32 s83, s60, 4096
    buffer_load_dwordx4 v[76:79], v2, s[40:43], s83 offen nt
    s_waitcnt vmcnt(2)
    s_xor_b32 s83, s60, 8192
    buffer_load_dwordx4 v[80:83], v2, s[40:43], s83 offen nt
    ds_read_b128 v[56:59], v152 offset:4160
    ds_read_b128 v[60:63], v153 offset:4160
    ds_read_b128 v[64:67], v154 offset:4160
    ds_read_b128 v[68:71], v155 offset:4160
    s_waitcnt vmcnt(2)
    s_xor_b32 s83, s60, 12288
    buffer_load_dwordx4 v[84:87], v2, s[40:43], s83 offen nt
    s_mov_b32 s82, 0
L_sqn:
    ds_read_b32 v152, v4 offset:68
    s_add_u32 s82, s82, 1
    s_cmp_gt_u32 s82, 4194304
    s_cbranch_scc1 L_sqn_done
    s_waitcnt lgkmcnt(0)
    v_cmp_eq_u32 vcc, 1, v152
    s_cbranch_vccnz L_sqn_done
    s_sleep 1
    s_branch L_sqn
L_sqn_done:
    ds_read_b128 v[136:139], v7 offset:1536
    ds_read_b128 v[140:143], v7 offset:1600
    ds_read_b128 v[144:147], v7 offset:1664
    ds_read_b128 v[148:151], v7 offset:1728
    s_waitcnt lgkmcnt(0)
    v_mfma_f32_16x16x32_bf16 v[152:155], v[8:11], v[136:139], 0
    v_mfma_f32_16x16x32_bf16 v[156:159], v[24:27], v[136:139], 0
    v_mfma_f32_16x16x32_bf16 v[160:163], v[40:43], v[136:139], 0
    v_mfma_f32_16x16x32_bf16 v[164:167], v[56:59], v[136:139], 0
    v_mfma_f32_16x16x32_bf16 v[152:155], v[12:15], v[140:143], v[152:155]
    v_mfma_f32_16x16x32_bf16 v[156:159], v[28:31], v[140:143], v[156:159]
    v_mfma_f32_16x16x32_bf16 v[160:163], v[44:47], v[140:143], v[160:163]
    v_mfma_f32_16x16x32_bf16 v[164:167], v[60:63], v[140:143], v[164:167]
    v_mfma_f32_16x16x32_bf16 v[152:155], v[16:19], v[144:147], v[152:155]
    v_mfma_f32_16x16x32_bf16 v[156:159], v[32:35], v[144:147], v[156:159]
    v_mfma_f32_16x16x32_bf16 v[160:163], v[48:51], v[144:147], v[160:163]
    v_mfma_f32_16x16x32_bf16 v[164:167], v[64:67], v[144:147], v[164:167]
    v_mfma_f32_16x16x32_bf16 v[152:155], v[20:23], v[148:151], v[152:155]
    v_mfma_f32_16x16x32_bf16 v[156:159], v[36:39], v[148:151], v[156:159]
    v_mfma_f32_16x16x32_bf16 v[160:163], v[52:55], v[148:151], v[160:163]
    v_mfma_f32_16x16x32_bf16 v[164:167], v[68:71], v[148:151], v[164:167]
    s_waitcnt vmcnt(2)
    s_xor_b32 s83, s60, 16384
    buffer_load_dwordx4 v[88:91], v2, s[40:43], s83 offen nt
    s_mov_b32 s34, 0x3db504f3
    s_lshl_b32 s35, s33, 3
    v_lshl_add_u32 v7, v0, 6, s35
    v_cvt_pk_bf16_f32 v152, 0, v152
    v_cvt_pk_bf16_f32 v153, 0, v153
    v_cvt_pk_bf16_f32 v154, 0, v154
    v_cvt_pk_bf16_f32 v155, 0, v155
    v_cvt_pk_bf16_f32 v156, 0, v156
    v_cvt_pk_bf16_f32 v157, 0, v157
    v_cvt_pk_bf16_f32 v158, 0, v158
    v_cvt_pk_bf16_f32 v159, 0, v159
    v_cvt_pk_bf16_f32 v160, 0, v160
    v_cvt_pk_bf16_f32 v161, 0, v161
    v_cvt_pk_bf16_f32 v162, 0, v162
    v_cvt_pk_bf16_f32 v163, 0, v163
    v_cvt_pk_bf16_f32 v164, 0, v164
    v_cvt_pk_bf16_f32 v165, 0, v165
    v_cvt_pk_bf16_f32 v166, 0, v166
    v_cvt_pk_bf16_f32 v167, 0, v167
    v_mul_f32 v152, s34, v152
    v_mul_f32 v153, s34, v153
    v_mul_f32 v154, s34, v154
    v_mul_f32 v155, s34, v155
    v_mul_f32 v156, s34, v156
    v_mul_f32 v157, s34, v157
    v_mul_f32 v158, s34, v158
    v_mul_f32 v159, s34, v159
    v_mul_f32 v160, s34, v160
    v_mul_f32 v161, s34, v161
    v_mul_f32 v162, s34, v162
    v_mul_f32 v163, s34, v163
    v_mul_f32 v164, s34, v164
    v_mul_f32 v165, s34, v165
    v_mul_f32 v166, s34, v166
    v_mul_f32 v167, s34, v167
    v_cvt_pk_bf16_f32 v152, 0, v152
    v_cvt_pk_bf16_f32 v153, 0, v153
    v_cvt_pk_bf16_f32 v154, 0, v154
    v_cvt_pk_bf16_f32 v155, 0, v155
    v_cvt_pk_bf16_f32 v156, 0, v156
    v_cvt_pk_bf16_f32 v157, 0, v157
    v_cvt_pk_bf16_f32 v158, 0, v158
    v_cvt_pk_bf16_f32 v159, 0, v159
    v_cvt_pk_bf16_f32 v160, 0, v160
    v_cvt_pk_bf16_f32 v161, 0, v161
    v_cvt_pk_bf16_f32 v162, 0, v162
    v_cvt_pk_bf16_f32 v163, 0, v163
    v_cvt_pk_bf16_f32 v164, 0, v164
    v_cvt_pk_bf16_f32 v165, 0, v165
    v_cvt_pk_bf16_f32 v166, 0, v166
    v_cvt_pk_bf16_f32 v167, 0, v167
    v_max3_f32 v148, v152, v153, v154
    v_max3_f32 v148, v148, v155, v156
    v_max3_f32 v148, v148, v157, v158
    v_max3_f32 v148, v148, v159, v160
    v_max3_f32 v148, v148, v161, v162
    v_max3_f32 v148, v148, v163, v164
    v_max3_f32 v148, v148, v165, v166
    v_max_f32 v148, v148, v167
    v_mov_b32 v149, v148
    s_nop 1
    v_permlane16_swap_b32 v148, v149
    v_max_f32 v148, v148, v149
    v_mov_b32 v149, v148
    s_nop 1
    v_permlane32_swap_b32 v148, v149
    v_max_f32 v148, v148, v149
    s_waitcnt vmcnt(2)
    s_xor_b32 s83, s60, 20480
    buffer_load_dwordx4 v[92:95], v2, s[40:43], s83 offen nt
    s_mov_b32 s34, 0x3fb8aa3b
    v_sub_f32 v152, v152, v148
    v_sub_f32 v153, v153, v148
    v_sub_f32 v154, v154, v148
    v_sub_f32 v155, v155, v148
    v_sub_f32 v156, v156, v148
    v_sub_f32 v157, v157, v148
    v_sub_f32 v158, v158, v148
    v_sub_f32 v159, v159, v148
    v_sub_f32 v160, v160, v148
    v_sub_f32 v161, v161, v148
    v_sub_f32 v162, v162, v148
    v_sub_f32 v163, v163, v148
    v_sub_f32 v164, v164, v148
    v_sub_f32 v165, v165, v148
    v_sub_f32 v166, v166, v148
    v_sub_f32 v167, v167, v148
    v_mul_f32 v152, s34, v152
    v_mul_f32 v153, s34, v153
    v_mul_f32 v154, s34, v154
    v_mul_f32 v155, s34, v155
    v_mul_f32 v156, s34, v156
    v_mul_f32 v157, s34, v157
    v_mul_f32 v158, s34, v158
    v_mul_f32 v159, s34, v159
    v_mul_f32 v160, s34, v160
    v_mul_f32 v161, s34, v161
    v_mul_f32 v162, s34, v162
    v_mul_f32 v163, s34, v163
    v_mul_f32 v164, s34, v164
    v_mul_f32 v165, s34, v165
    v_mul_f32 v166, s34, v166
    v_mul_f32 v167, s34, v167
    v_exp_f32 v152, v152
    v_exp_f32 v153, v153
    v_exp_f32 v154, v154
    v_exp_f32 v155, v155
    v_exp_f32 v156, v156
    v_exp_f32 v157, v157
    v_exp_f32 v158, v158
    v_exp_f32 v159, v159
    v_exp_f32 v160, v160
    v_exp_f32 v161, v161
    v_exp_f32 v162, v162
    v_exp_f32 v163, v163
    v_exp_f32 v164, v164
    v_exp_f32 v165, v165
    v_exp_f32 v166, v166
    v_exp_f32 v167, v167
    v_cvt_pk_bf16_f32 v56, v152, v152
    v_cvt_pk_bf16_f32 v57, v153, v153
    v_cvt_pk_bf16_f32 v58, v154, v154
    v_cvt_pk_bf16_f32 v59, v155, v155
    v_cvt_pk_bf16_f32 v60, v156, v156
    v_cvt_pk_bf16_f32 v61, v157, v157
    v_cvt_pk_bf16_f32 v62, v158, v158
    v_cvt_pk_bf16_f32 v63, v159, v159
    v_cvt_pk_bf16_f32 v64, v160, v160
    v_cvt_pk_bf16_f32 v65, v161, v161
    v_cvt_pk_bf16_f32 v66, v162, v162
    v_cvt_pk_bf16_f32 v67, v163, v163
    v_cvt_pk_bf16_f32 v68, v164, v164
    v_cvt_pk_bf16_f32 v69, v165, v165
    v_cvt_pk_bf16_f32 v70, v166, v166
    v_cvt_pk_bf16_f32 v71, v167, v167
    v_add_f32 v152, v152, v160
    v_add_f32 v153, v153, v161
    v_add_f32 v154, v154, v162
    v_add_f32 v155, v155, v163
    v_add_f32 v156, v156, v164
    v_add_f32 v157, v157, v165
    v_add_f32 v158, v158, v166
    v_add_f32 v159, v159, v167
    v_add_f32 v152, v152, v156
    v_add_f32 v153, v153, v157
    v_add_f32 v154, v154, v158
    v_add_f32 v155, v155, v159
    v_add_f32 v152, v152, v154
    v_add_f32 v153, v153, v155
    v_add_f32 v149, v152, v153
    v_mov_b32 v150, v149
    s_nop 1
    v_permlane16_swap_b32 v149, v150
    v_add_f32 v149, v149, v150
    v_mov_b32 v150, v149
    s_nop 1
    v_permlane32_swap_b32 v149, v150
    v_add_f32 v149, v149, v150
    v_mov_b32 v150, 1
    s_mov_b64 exec, 3
    ds_write_b64 v7, v[148:149] offset:384
    s_mov_b64 exec, 1
    ds_add_u32 v4, v150 offset:72
    s_mov_b64 exec, -1
    s_waitcnt vmcnt(2)
    s_xor_b32 s83, s60, 24576
    buffer_load_dwordx4 v[96:99], v2, s[40:43], s83 offen nt
    v_add_u32 v7, s57, v2
    v_add_u32 v148, 8704, v2
    s_lshl3_add_u32 s35, s31, s32
    s_lshl_b32 s34, s30, 5
    s_add_u32 s34, s34, s35
    s_lshl_b32 s34, s34, 8
    s_add_u32 s34, s34, 139264
    v_and_b32 v157, 1, v0
    v_lshlrev_b32 v161, 12, v157
    v_lshrrev_b32 v158, 1, v0
    v_lshl_add_u32 v149, v158, 3, v161
    v_add_u32 v149, s34, v149
    s_lshl_b32 s34, s30, 13
    s_lshl4_add_u32 s34, s35, s34
    s_add_u32 s34, s34, 270336
    v_lshrrev_b32 v158, 2, v0
    v_lshl_add_u32 v161, v158, 8, v161
    v_and_b32 v158, 2, v0
    v_lshl_add_u32 v161, v158, 2, v161
    v_add_u32 v161, s34, v161
    s_lshl_b32 s34, s33, 2
    v_lshl_add_u32 v157, v157, 5, s34
    v_mov_b32 v140, 0xffff
    v_mov_b32 v141, 0xffff0000
    v_cndmask_b32_e64 v136, 0, v140, s[64:65]
    v_cndmask_b32_e64 v136, v136, v141, s[66:67]
    v_cndmask_b32_e64 v137, 0, v140, s[68:69]
    v_cndmask_b32_e64 v137, v137, v141, s[70:71]
    v_cndmask_b32_e64 v138, 0, v140, s[72:73]
    v_cndmask_b32_e64 v138, v138, v141, s[74:75]
    v_cndmask_b32_e64 v139, 0, v140, s[76:77]
    v_cndmask_b32_e64 v139, v139, v141, s[78:79]
    v_and_b32 v40, v136, v56
    v_and_b32 v41, v137, v56
    v_and_b32 v42, v138, v56
    v_and_b32 v43, v139, v56
    s_nop 1
    v_mfma_f32_16x16x32_bf16 v[144:147], v[72:75], v[40:43], 0
    v_and_b32 v44, v136, v57
    v_and_b32 v45, v137, v57
    v_and_b32 v46, v138, v57
    v_and_b32 v47, v139, v57
    s_nop 1
    v_mfma_f32_16x16x32_bf16 v[144:147], v[76:79], v[44:47], v[144:147]
    v_and_b32 v48, v136, v58
    v_and_b32 v49, v137, v58
    v_and_b32 v50, v138, v58
    v_and_b32 v51, v139, v58
    s_nop 1
    v_mfma_f32_16x16x32_bf16 v[144:147], v[80:83], v[48:51], v[144:147]
    v_and_b32 v52, v136, v59
    v_and_b32 v53, v137, v59
    v_and_b32 v54, v138, v59
    v_and_b32 v55, v139, v59
    s_nop 1
    v_mfma_f32_16x16x32_bf16 v[144:147], v[84:87], v[52:55], v[144:147]
    v_and_b32 v40, v136, v60
    v_and_b32 v41, v137, v60
    v_and_b32 v42, v138, v60
    v_and_b32 v43, v139, v60
    s_waitcnt vmcnt(2)
    s_xor_b32 s83, s60, 28672
    buffer_load_dwordx4 v[100:103], v2, s[40:43], s83 offen nt
    v_mfma_f32_16x16x32_bf16 v[144:147], v[88:91], v[40:43], v[144:147]
    v_and_b32 v44, v136, v61
    v_and_b32 v45, v137, v61
    v_and_b32 v46, v138, v61
    v_and_b32 v47, v139, v61
    s_waitcnt vmcnt(2)
    s_xor_b32 s83, s60, 131072
    buffer_load_dwordx4 v[104:107], v2, s[40:43], s83 offen nt
    v_mfma_f32_16x16x32_bf16 v[144:147], v[92:95], v[44:47], v[144:147]
    v_and_b32 v48, v136, v62
    v_and_b32 v49, v137, v62
    v_and_b32 v50, v138, v62
    v_and_b32 v51, v139, v62
    s_waitcnt vmcnt(2)
    s_xor_b32 s83, s60, 135168
    buffer_load_dwordx4 v[108:111], v2, s[40:43], s83 offen nt
    v_mfma_f32_16x16x32_bf16 v[144:147], v[96:99], v[48:51], v[144:147]
    v_and_b32 v52, v136, v63
    v_and_b32 v53, v137, v63
    v_and_b32 v54, v138, v63
    v_and_b32 v55, v139, v63
    s_waitcnt vmcnt(2)
    s_xor_b32 s83, s60, 139264
    buffer_load_dwordx4 v[112:115], v2, s[40:43], s83 offen nt
    v_mfma_f32_16x16x32_bf16 v[144:147], v[100:103], v[52:55], v[144:147]
    v_and_b32 v40, v136, v64
    v_and_b32 v41, v137, v64
    v_and_b32 v42, v138, v64
    v_and_b32 v43, v139, v64
    s_waitcnt vmcnt(2)
    s_xor_b32 s83, s60, 143360
    buffer_load_dwordx4 v[116:119], v2, s[40:43], s83 offen nt
    v_mfma_f32_16x16x32_bf16 v[144:147], v[104:107], v[40:43], v[144:147]
    v_and_b32 v44, v136, v65
    v_and_b32 v45, v137, v65
    v_and_b32 v46, v138, v65
    v_and_b32 v47, v139, v65
    s_waitcnt vmcnt(2)
    s_xor_b32 s83, s60, 147456
    buffer_load_dwordx4 v[24:27], v2, s[40:43], s83 offen nt
    v_mfma_f32_16x16x32_bf16 v[144:147], v[108:111], v[44:47], v[144:147]
    v_and_b32 v48, v136, v66
    v_and_b32 v49, v137, v66
    v_and_b32 v50, v138, v66
    v_and_b32 v51, v139, v66
    s_waitcnt vmcnt(2)
    s_xor_b32 s83, s60, 151552
    buffer_load_dwordx4 v[28:31], v2, s[40:43], s83 offen nt
    v_mfma_f32_16x16x32_bf16 v[144:147], v[112:115], v[48:51], v[144:147]
    v_and_b32 v52, v136, v67
    v_and_b32 v53, v137, v67
    v_and_b32 v54, v138, v67
    v_and_b32 v55, v139, v67
    s_waitcnt vmcnt(2)
    s_xor_b32 s83, s60, 155648
    buffer_load_dwordx4 v[32:35], v2, s[40:43], s83 offen nt
    v_mfma_f32_16x16x32_bf16 v[144:147], v[116:119], v[52:55], v[144:147]
    v_and_b32 v40, v136, v68
    v_and_b32 v41, v137, v68
    v_and_b32 v42, v138, v68
    v_and_b32 v43, v139, v68
    s_waitcnt vmcnt(2)
    s_xor_b32 s83, s60, 159744
    buffer_load_dwordx4 v[36:39], v2, s[40:43], s83 offen nt
    s_barrier
    v_mfma_f32_16x16x32_bf16 v[144:147], v[24:27], v[40:43], v[144:147]
    v_and_b32 v44, v136, v69
    v_and_b32 v45, v137, v69
    v_and_b32 v46, v138, v69
    v_and_b32 v47, v139, v69
    v_min_u32 v128, 575, v124
    v_mul_u32_u24 v128, 9216, v128
    v_add_u32 v128, v128, v125
    s_mov_b64 exec, 0x1ff
    global_load_dword v129, v128, s[16:17]
    s_mov_b64 exec, -1
    v_add_u32 v124, 1, v124
    s_waitcnt vmcnt(3)
    v_min_u32 v128, 575, v124
    v_mul_u32_u24 v128, 9216, v128
    v_add_u32 v128, v128, v125
    s_mov_b64 exec, 0x1ff
    global_load_dword v129, v128, s[16:17]
    s_mov_b64 exec, -1
    v_add_u32 v124, 1, v124
    v_mfma_f32_16x16x32_bf16 v[144:147], v[28:31], v[44:47], v[144:147]
    v_and_b32 v48, v136, v70
    v_and_b32 v49, v137, v70
    v_and_b32 v50, v138, v70
    v_and_b32 v51, v139, v70
    s_mov_b32 s82, 0
L_sfn:
    ds_read_b32 v158, v4 offset:80
    s_add_u32 s82, s82, 1
    s_cmp_gt_u32 s82, 4194304
    s_cbranch_scc1 L_sfn_done
    s_waitcnt lgkmcnt(0)
    v_cmp_ne_u32 vcc, 0, v158
    s_cbranch_vccnz L_sfn_done
    s_sleep 1
    s_branch L_sfn
L_sfn_done:
    v_readfirstlane_b32 s54, v158
    ds_read_b32 v158, v157 offset:128
    ds_read_b32 v160, v4 offset:76
    s_waitcnt vmcnt(3)
    v_min_u32 v128, 575, v124
    v_mul_u32_u24 v128, 9216, v128
    v_add_u32 v128, v128, v125
    s_mov_b64 exec, 0x1ff
    global_load_dword v129, v128, s[16:17]
    s_mov_b64 exec, -1
    v_add_u32 v124, 1, v124
    v_mfma_f32_16x16x32_bf16 v[144:147], v[32:35], v[48:51], v[144:147]
    v_and_b32 v52, v136, v71
    v_and_b32 v53, v137, v71
    v_and_b32 v54, v138, v71
    v_and_b32 v55, v139, v71
    s_waitcnt lgkmcnt(0)
    s_waitcnt vmcnt(3)
    v_mfma_f32_16x16x32_bf16 v[144:147], v[36:39], v[52:55], v[144:147]
    ds_read2_b32 v[152:153], v4 offset0:26 offset1:21
    s_nop 6
    v_pk_mul_f32 v[144:145], v[144:145], v[158:159] op_sel_hi:[1,0]
    v_pk_mul_f32 v[146:147], v[146:147], v[158:159] op_sel_hi:[1,0]
    ds_write_b128 v7, v[144:147]
    s_mov_b64 exec, 1
    ds_add_rtn_u32 v159, v4, v150 offset:84
    s_mov_b64 exec, -1
    ds_read_b128 v[8:11], v148 offset:0
    ds_read_b128 v[12:15], v148 offset:8320
    ds_read_b128 v[16:19], v148 offset:16640
    ds_read_b128 v[20:23], v148 offset:24960
    ds_read_b128 v[24:27], v148 offset:33280
    ds_read_b128 v[28:31], v148 offset:41600
    ds_read_b128 v[32:35], v148 offset:49920
    ds_read_b128 v[36:39], v148 offset:58240
    s_waitcnt lgkmcnt(8)
    v_readfirstlane_b32 s34, v159
    v_readfirstlane_b32 s63, v152
    s_cmp_eq_u32 s34, 7
    s_cbranch_scc0 L_noredn
L_redn:
    s_waitcnt lgkmcnt(6)
    v_pk_add_f32 v[8:9], v[8:9], v[12:13]
    v_pk_add_f32 v[10:11], v[10:11], v[14:15]
    s_waitcnt lgkmcnt(5)
    v_pk_add_f32 v[8:9], v[8:9], v[16:17]
    v_pk_add_f32 v[10:11], v[10:11], v[18:19]
    s_waitcnt lgkmcnt(4)
    v_pk_add_f32 v[8:9], v[8:9], v[20:21]
    v_pk_add_f32 v[10:11], v[10:11], v[22:23]
    s_waitcnt lgkmcnt(3)
    v_pk_add_f32 v[8:9], v[8:9], v[24:25]
    v_pk_add_f32 v[10:11], v[10:11], v[26:27]
    s_waitcnt lgkmcnt(2)
    v_pk_add_f32 v[8:9], v[8:9], v[28:29]
    v_pk_add_f32 v[10:11], v[10:11], v[30:31]
    s_waitcnt lgkmcnt(1)
    v_pk_add_f32 v[8:9], v[8:9], v[32:33]
    v_pk_add_f32 v[10:11], v[10:11], v[34:35]
    s_waitcnt lgkmcnt(0)
    v_pk_add_f32 v[8:9], v[8:9], v[36:37]
    v_pk_add_f32 v[10:11], v[10:11], v[38:39]
    v_cvt_pk_bf16_f32 v8, v8, v9
    v_cvt_pk_bf16_f32 v9, v10, v11
    global_store_dwordx2 v161, v[8:9], s[28:29]
    s_cmp_eq_u32 s54, 2
    s_cbranch_scc1 L_noredn
    global_store_dwordx2 v149, v[8:9], s[28:29] sc1
L_noredn:
    s_barrier
    v_min_u32 v128, 575, v124
    v_mul_u32_u24 v128, 9216, v128
    v_add_u32 v128, v128, v125
    s_mov_b32 exec_lo, 0xffffffff
    s_mov_b32 exec_hi, 0x1fff
    global_load_dword v129, v128, s[16:17]
    s_mov_b64 exec, -1
    v_add_u32 v124, 5, v124
    s_branch L_fin
L_helper:
    s_mov_b32 s33, 8
    v_lshlrev_b32 v7, 2, v0
    ds_write_b32 v7, v4
    v_mov_b32 v161, 135172
    s_waitcnt lgkmcnt(0)
    global_load_dword v160, v161, s[28:29] sc1
    s_barrier
L_not:
    s_lshr_b32 s34, s64, 2
    s_lshl3_add_u32 s34, s34, s65
    s_and_b32 s35, s64, 3
    s_lshl2_add_u32 s34, s34, s35
    s_lshl_b32 s34, s34, 8
    v_and_b32 v143, 1, v0
    v_lshlrev_b32 v140, 12, v143
    v_lshrrev_b32 v144, 1, v6
    v_lshl_add_u32 v140, v144, 6, v140
    v_lshl_add_u32 v140, v5, 4, v140
    v_add_u32 v140, s34, v140
    s_lshl_b32 s34, s30, 13
    s_lshl_b32 s66, s67, 8
    s_add_u32 s34, s34, s66
    s_add_u32 s34, s34, 139264
    v_lshrrev_b32 v141, 5, v0
    v_lshlrev_b32 v141, 12, v141
    v_and_b32 v144, 31, v0
    v_lshl_add_u32 v141, v144, 3, v141
    v_add_u32 v141, s34, v141
    s_lshl4_add_u32 s34, s30, s67
    s_lshl_b32 s34, s34, 4
    s_add_u32 s34, s34, 131072
    v_add_u32 v142, s34, v0
    s_mul_i32 s34, s65, 288
    v_mul_u32_u24 v143, 1152, v143
    v_lshl_add_u32 v143, v5, 3, v143
    v_add_u32 v143, s34, v143
    v_lshrrev_b32 v21, 2, v0
    v_lshlrev_b32 v8, 7, v21
    v_bfe_u32 v21, v0, 3, 2
    v_lshl_add_u32 v8, v21, 5, v8
    v_and_b32 v21, 3, v0
    v_lshl_add_u32 v8, v21, 3, v8
    v_add_u32 v8, 140800, v8
    v_xor_b32 v9, 32, v8
    v_xor_b32 v10, 64, v8
    v_xor_b32 v11, 96, v8
    v_mov_b32 v145, v120
    s_waitcnt vmcnt(3)
    v_lshlrev_b32 v24, 16, v12
    v_and_b32 v25, 0xffff0000, v12
    v_lshlrev_b32 v26, 16, v13
    v_and_b32 v27, 0xffff0000, v13
    v_lshlrev_b32 v28, 16, v14
    v_and_b32 v29, 0xffff0000, v14
    v_lshlrev_b32 v30, 16, v15
    v_and_b32 v31, 0xffff0000, v15
    v_lshlrev_b32 v32, 16, v16
    v_and_b32 v33, 0xffff0000, v16
    v_lshlrev_b32 v34, 16, v17
    v_and_b32 v35, 0xffff0000, v17
    v_lshlrev_b32 v36, 16, v18
    v_and_b32 v37, 0xffff0000, v18
    v_lshlrev_b32 v38, 16, v19
    v_and_b32 v39, 0xffff0000, v19
    v_lshlrev_b32 v40, 16, v20
    v_and_b32 v41, 0xffff0000, v20
    v_add_f32 v42, v24, v25
    v_add_f32 v42, v42, v26
    v_add_f32 v42, v42, v27
    v_add_f32 v42, v42, v28
    v_add_f32 v42, v42, v29
    v_add_f32 v42, v42, v30
    v_add_f32 v42, v42, v31
    v_add_f32 v42, v42, v32
    v_add_f32 v42, v42, v33
    v_add_f32 v42, v42, v34
    v_add_f32 v42, v42, v35
    v_add_f32 v42, v42, v36
    v_add_f32 v42, v42, v37
    v_add_f32 v42, v42, v38
    v_add_f32 v42, v42, v39
    v_add_f32 v42, v42, v40
    v_add_f32 v42, v42, v41
    s_nop 1
    v_add_f32 v42, v42, v42 quad_perm:[1,0,3,2] row_mask:0xf bank_mask:0xf
    s_nop 1
    v_add_f32 v42, v42, v42 quad_perm:[2,3,0,1] row_mask:0xf bank_mask:0xf
    s_nop 1
    v_add_f32 v42, v42, v42 row_half_mirror row_mask:0xf bank_mask:0xf
    s_nop 1
    v_add_f32 v42, v42, v42 row_mirror row_mask:0xf bank_mask:0xf
    v_mov_b32 v43, v42
    s_nop 1
    v_permlane16_swap_b32 v42, v43
    v_add_f32 v42, v42, v43
    v_mul_f32 v42, 0x3ae38e39, v42
    v_sub_f32 v44, v24, v42
    v_mul_f32 v43, v44, v44
    v_sub_f32 v44, v25, v42
    v_fmac_f32 v43, v44, v44
    v_sub_f32 v44, v26, v42
    v_fmac_f32 v43, v44, v44
    v_sub_f32 v44, v27, v42
    v_fmac_f32 v43, v44, v44
    v_sub_f32 v44, v28, v42
    v_fmac_f32 v43, v44, v44
    v_sub_f32 v44, v29, v42
    v_fmac_f32 v43, v44, v44
    v_sub_f32 v44, v30, v42
    v_fmac_f32 v43, v44, v44
    v_sub_f32 v44, v31, v42
    v_fmac_f32 v43, v44, v44
    v_sub_f32 v44, v32, v42
    v_fmac_f32 v43, v44, v44
    v_sub_f32 v44, v33, v42
    v_fmac_f32 v43, v44, v44
    v_sub_f32 v44, v34, v42
    v_fmac_f32 v43, v44, v44
    v_sub_f32 v44, v35, v42
    v_fmac_f32 v43, v44, v44
    v_sub_f32 v44, v36, v42
    v_fmac_f32 v43, v44, v44
    v_sub_f32 v44, v37, v42
    v_fmac_f32 v43, v44, v44
    v_sub_f32 v44, v38, v42
    v_fmac_f32 v43, v44, v44
    v_sub_f32 v44, v39, v42
    v_fmac_f32 v43, v44, v44
    v_sub_f32 v44, v40, v42
    v_fmac_f32 v43, v44, v44
    v_sub_f32 v44, v41, v42
    v_fmac_f32 v43, v44, v44
    s_nop 1
    v_add_f32 v43, v43, v43 quad_perm:[1,0,3,2] row_mask:0xf bank_mask:0xf
    s_nop 1
    v_add_f32 v43, v43, v43 quad_perm:[2,3,0,1] row_mask:0xf bank_mask:0xf
    s_nop 1
    v_add_f32 v43, v43, v43 row_half_mirror row_mask:0xf bank_mask:0xf
    s_nop 1
    v_add_f32 v43, v43, v43 row_mirror row_mask:0xf bank_mask:0xf
    v_mov_b32 v44, v43
    s_nop 1
    v_permlane16_swap_b32 v43, v44
    v_add_f32 v43, v43, v44
    v_mul_f32 v43, 0x3ae38e39, v43
    v_cvt_pk_bf16_f32 v42, 0, v42
    v_cvt_pk_bf16_f32 v43, 0, v43
    v_add_f32 v43, 0x3727c5ac, v43
    v_cvt_pk_bf16_f32 v43, 0, v43
    v_sqrt_f32 v43, v43
    s_nop 0
    v_cvt_pk_bf16_f32 v43, 0, v43
    v_rcp_f32 v43, v43
    v_sub_f32 v24, v24, v42
    v_sub_f32 v25, v25, v42
    v_sub_f32 v26, v26, v42
    v_sub_f32 v27, v27, v42
    v_sub_f32 v28, v28, v42
    v_sub_f32 v29, v29, v42
    v_sub_f32 v30, v30, v42
    v_sub_f32 v31, v31, v42
    v_sub_f32 v32, v32, v42
    v_sub_f32 v33, v33, v42
    v_sub_f32 v34, v34, v42
    v_sub_f32 v35, v35, v42
    v_sub_f32 v36, v36, v42
    v_sub_f32 v37, v37, v42
    v_sub_f32 v38, v38, v42
    v_sub_f32 v39, v39, v42
    v_sub_f32 v40, v40, v42
    v_sub_f32 v41, v41, v42
    v_cvt_pk_bf16_f32 v24, 0, v24
    v_cvt_pk_bf16_f32 v25, 0, v25
    v_cvt_pk_bf16_f32 v26, 0, v26
    v_cvt_pk_bf16_f32 v27, 0, v27
    v_cvt_pk_bf16_f32 v28, 0, v28
    v_cvt_pk_bf16_f32 v29, 0, v29
    v_cvt_pk_bf16_f32 v30, 0, v30
    v_cvt_pk_bf16_f32 v31, 0, v31
    v_cvt_pk_bf16_f32 v32, 0, v32
    v_cvt_pk_bf16_f32 v33, 0, v33
    v_cvt_pk_bf16_f32 v34, 0, v34
    v_cvt_pk_bf16_f32 v35, 0, v35
    v_cvt_pk_bf16_f32 v36, 0, v36
    v_cvt_pk_bf16_f32 v37, 0, v37
    v_cvt_pk_bf16_f32 v38, 0, v38
    v_cvt_pk_bf16_f32 v39, 0, v39
    v_cvt_pk_bf16_f32 v40, 0, v40
    v_cvt_pk_bf16_f32 v41, 0, v41
    v_mul_f32 v24, v24, v43
    v_mul_f32 v25, v25, v43
    v_mul_f32 v26, v26, v43
    v_mul_f32 v27, v27, v43
    v_mul_f32 v28, v28, v43
    v_mul_f32 v29, v29, v43
    v_mul_f32 v30, v30, v43
    v_mul_f32 v31, v31, v43
    v_mul_f32 v32, v32, v43
    v_mul_f32 v33, v33, v43
    v_mul_f32 v34, v34, v43
    v_mul_f32 v35, v35, v43
    v_mul_f32 v36, v36, v43
    v_mul_f32 v37, v37, v43
    v_mul_f32 v38, v38, v43
    v_mul_f32 v39, v39, v43
    v_mul_f32 v40, v40, v43
    v_mul_f32 v41, v41, v43
    v_cvt_pk_bf16_f32 v12, v24, v25
    v_cvt_pk_bf16_f32 v13, v26, v27
    v_cvt_pk_bf16_f32 v14, v28, v29
    v_cvt_pk_bf16_f32 v15, v30, v31
    v_cvt_pk_bf16_f32 v16, v32, v33
    v_cvt_pk_bf16_f32 v17, v34, v35
    v_cvt_pk_bf16_f32 v18, v36, v37
    v_cvt_pk_bf16_f32 v19, v38, v39
    v_cvt_pk_bf16_f32 v20, v40, v41
    ds_write_b32 v1, v12 offset:2048
    ds_write_b32 v1, v13 offset:2052
    ds_write_b32 v1, v14 offset:2056
    ds_write_b32 v1, v15 offset:2060
    ds_write_b32 v1, v16 offset:2064
    ds_write_b32 v1, v17 offset:2068
    ds_write_b32 v1, v18 offset:2072
    ds_write_b32 v1, v19 offset:2076
    ds_write_b32 v1, v20 offset:2080
    s_waitcnt lgkmcnt(0)
    ds_read_b64 v[12:13], v143 offset:2048
    ds_read_b64 v[14:15], v143 offset:2080
    ds_read_b64 v[16:17], v143 offset:2112
    ds_read_b64 v[18:19], v143 offset:2144
    ds_read_b64 v[20:21], v143 offset:2176
    ds_read_b64 v[22:23], v143 offset:2208
    ds_read_b64 v[24:25], v143 offset:2240
    ds_read_b64 v[26:27], v143 offset:2272
    ds_read_b64 v[28:29], v143 offset:2304
    s_waitcnt vmcnt(0)
    v_add_u32 v160, 0x9e3779b9, v160
    v_max_u32 v160, 1, v160
    s_getreg_b32 s66, hwreg(HW_REG_XCC_ID, 0, 4)
    v_and_b32 v134, -16, v160
    v_or_b32 v134, s66, v134
    s_lshl_b32 s66, s66, 12
    s_and_b32 s34, s2, 7
    s_lshl_b32 s34, s34, 7
    s_add_u32 s34, s34, 137216
    v_and_b32 v135, 31, v0
    v_lshl_add_u32 v135, v135, 2, s34
    s_lshr_b32 s35, s2, 3
    s_lshl_b64 exec, 1, s35
    global_store_dword v135, v134, s[28:29]
    s_mov_b64 exec, -1
    s_mov_b32 s82, 0
L_hw:
    ds_read_b32 v30, v4 offset:64
    s_add_u32 s82, s82, 1
    s_cmp_gt_u32 s82, 4194304
    s_cbranch_scc1 L_hw_done
    s_waitcnt lgkmcnt(0)
    v_cmp_eq_u32 vcc, 8, v30
    s_cbranch_vccnz L_hw_done
    s_sleep 1
    s_branch L_hw
L_hw_done:
    ds_read_b64_tr_b16 v[32:33], v8 offset:0
    ds_read_b64_tr_b16 v[34:35], v8 offset:2048
    ds_read_b64_tr_b16 v[36:37], v8 offset:4096
    ds_read_b64_tr_b16 v[38:39], v8 offset:6144
    ds_read_b64_tr_b16 v[40:41], v8 offset:8192
    ds_read_b64_tr_b16 v[42:43], v8 offset:10240
    ds_read_b64_tr_b16 v[44:45], v8 offset:12288
    ds_read_b64_tr_b16 v[46:47], v8 offset:14336
    ds_read_b64_tr_b16 v[48:49], v8 offset:16384
    ds_read_b64_tr_b16 v[52:53], v9 offset:0
    ds_read_b64_tr_b16 v[54:55], v9 offset:2048
    ds_read_b64_tr_b16 v[56:57], v9 offset:4096
    ds_read_b64_tr_b16 v[58:59], v9 offset:6144
    ds_read_b64_tr_b16 v[60:61], v9 offset:8192
    ds_read_b64_tr_b16 v[62:63], v9 offset:10240
    ds_read_b64_tr_b16 v[64:65], v9 offset:12288
    ds_read_b64_tr_b16 v[66:67], v9 offset:14336
    ds_read_b64_tr_b16 v[68:69], v9 offset:16384
    ds_read_b64_tr_b16 v[72:73], v10 offset:0
    ds_read_b64_tr_b16 v[74:75], v10 offset:2048
    ds_read_b64_tr_b16 v[76:77], v10 offset:4096
    ds_read_b64_tr_b16 v[78:79], v10 offset:6144
    ds_read_b64_tr_b16 v[80:81], v10 offset:8192
    ds_read_b64_tr_b16 v[82:83], v10 offset:10240
    ds_read_b64_tr_b16 v[84:85], v10 offset:12288
    ds_read_b64_tr_b16 v[86:87], v10 offset:14336
    ds_read_b64_tr_b16 v[88:89], v10 offset:16384
    ds_read_b64_tr_b16 v[92:93], v11 offset:0
    ds_read_b64_tr_b16 v[94:95], v11 offset:2048
    ds_read_b64_tr_b16 v[96:97], v11 offset:4096
    ds_read_b64_tr_b16 v[98:99], v11 offset:6144
    ds_read_b64_tr_b16 v[100:101], v11 offset:8192
    ds_read_b64_tr_b16 v[102:103], v11 offset:10240
    ds_read_b64_tr_b16 v[104:105], v11 offset:12288
    ds_read_b64_tr_b16 v[106:107], v11 offset:14336
    ds_read_b64_tr_b16 v[108:109], v11 offset:16384
    ds_write_b32 v4, v160 offset:76
    v_mov_b32 v128, -1
    v_mov_b32 v129, -1
    v_and_b32 v130, 16, v0
    v_lshrrev_b32 v130, v130, v160
    v_and_b32 v131, 1, v0
    v_lshlrev_b32 v131, 4, v131
    v_lshrrev_b32 v131, v131, v160
    v_lshrrev_b32 v146, 12, v130
    v_bfe_u32 v136, v131, 12, 4
    v_lshrrev_b32 v147, 0, v130
    v_bfe_u32 v137, v131, 0, 4
    v_lshrrev_b32 v148, 4, v130
    v_bfe_u32 v138, v131, 4, 4
    v_lshrrev_b32 v149, 8, v130
    v_bfe_u32 v139, v131, 8, 4
    s_lshl_b32 s34, s30, 13
    s_lshl4_add_u32 s34, s67, s34
    s_add_u32 s34, s34, 270336
    v_lshrrev_b32 v132, 1, v0
    v_lshlrev_b32 v132, 8, v132
    v_and_b32 v133, 1, v0
    v_lshl_add_u32 v132, v133, 3, v132
    v_add_u32 v132, s34, v132
    s_waitcnt lgkmcnt(0)
    v_mfma_f32_16x16x32_bf16 v[112:115], v[32:35], v[12:15], 0
    v_mfma_f32_16x16x32_bf16 v[116:119], v[52:55], v[12:15], 0
    v_mfma_f32_16x16x32_bf16 v[120:123], v[72:75], v[12:15], 0
    v_mfma_f32_16x16x32_bf16 v[124:127], v[92:95], v[12:15], 0
    v_mfma_f32_16x16x32_bf16 v[112:115], v[36:39], v[16:19], v[112:115]
    v_mfma_f32_16x16x32_bf16 v[116:119], v[56:59], v[16:19], v[116:119]
    v_mfma_f32_16x16x32_bf16 v[120:123], v[76:79], v[16:19], v[120:123]
    v_mfma_f32_16x16x32_bf16 v[124:127], v[96:99], v[16:19], v[124:127]
    v_mfma_f32_16x16x32_bf16 v[112:115], v[40:43], v[20:23], v[112:115]
    v_mfma_f32_16x16x32_bf16 v[116:119], v[60:63], v[20:23], v[116:119]
    v_mfma_f32_16x16x32_bf16 v[120:123], v[80:83], v[20:23], v[120:123]
    v_mfma_f32_16x16x32_bf16 v[124:127], v[100:103], v[20:23], v[124:127]
    v_mfma_f32_16x16x32_bf16 v[112:115], v[44:47], v[24:27], v[112:115]
    v_mfma_f32_16x16x32_bf16 v[116:119], v[64:67], v[24:27], v[116:119]
    v_mfma_f32_16x16x32_bf16 v[120:123], v[84:87], v[24:27], v[120:123]
    v_mfma_f32_16x16x32_bf16 v[124:127], v[104:107], v[24:27], v[124:127]
    v_mfma_f32_16x16x16_bf16 v[112:115], v[48:49], v[28:29], v[112:115]
    v_mfma_f32_16x16x16_bf16 v[116:119], v[68:69], v[28:29], v[116:119]
    v_mfma_f32_16x16x16_bf16 v[120:123], v[88:89], v[28:29], v[120:123]
    v_mfma_f32_16x16x16_bf16 v[124:127], v[108:109], v[28:29], v[124:127]
    s_mov_b32 vcc_lo, 0xc000c
    s_mov_b32 vcc_hi, 0xc000c
    s_nop 3
    v_cndmask_b32 v112, v112, v116, vcc
    v_cndmask_b32 v113, v113, v117, vcc
    v_cndmask_b32 v114, v114, v118, vcc
    v_cndmask_b32 v115, v115, v119, vcc
    s_mov_b32 vcc_lo, 0x300030
    s_mov_b32 vcc_hi, 0x300030
    v_cndmask_b32 v112, v112, v120, vcc
    v_cndmask_b32 v113, v113, v121, vcc
    v_cndmask_b32 v114, v114, v122, vcc
    v_cndmask_b32 v115, v115, v123, vcc
    s_mov_b32 vcc_lo, 0xc000c0
    s_mov_b32 vcc_hi, 0xc000c0
    v_cndmask_b32 v112, v112, v124, vcc
    v_cndmask_b32 v113, v113, v125, vcc
    v_cndmask_b32 v114, v114, v126, vcc
    v_cndmask_b32 v115, v115, v127, vcc
    v_bfi_b32 v112, 15, v146, v112
    v_bfi_b32 v113, 15, v147, v113
    v_bfi_b32 v114, 15, v148, v114
    v_bfi_b32 v115, 15, v149, v115
    s_mov_b32 exec_lo, 0xff00ff
    s_mov_b32 exec_hi, 0xff00ff
    global_store_dwordx4 v140, v[112:115], s[28:29]
    s_mov_b64 exec, -1
    global_store_dwordx2 v132, v[128:129], s[28:29]
    v_add_u32 v133, 131072, v141
    global_load_dword v131, v133, s[28:29] sc1
    s_cmpk_lt_u32 s2, 72
    s_cbranch_scc0 L_nohbc
    s_andn2_b32 s34, s62, 3
    s_add_u32 s34, s34, s62
    s_lshl3_add_u32 s34, s34, s61
    s_lshl_b32 s34, s34, 8
    s_add_u32 s34, s34, 458752
    v_lshl_add_u32 v79, v0, 2, s34
    v_add_u32 v84, 8192, v79
    global_store_dword v79, v128, s[28:29] sc1
    global_store_dword v84, v128, s[28:29] sc1
L_nohbc:
    s_lshl1_add_u32 s34, s30, s31
    s_lshl_b32 s34, s34, 12
    v_lshl_add_u32 v13, v0, 4, s34
    v_mov_b32 v120, v145
    v_mov_b32 v150, 1
    v_lshlrev_b32 v15, 3, v0
    s_mov_b32 s68, 0
    s_mov_b32 s69, 0
    s_mov_b32 s70, 0
    s_mov_b32 s82, 0
    s_waitcnt vmcnt(0)
L_pq:
    global_load_dword v33, v135, s[28:29] sc1
    s_cmp_lg_u32 s69, 0
    s_cbranch_scc1 L_pq_h
    v_add_u32 v14, s70, v13
    global_load_dwordx4 v[16:19], v14, s[28:29] offset:0 sc1
    global_load_dwordx4 v[20:23], v14, s[28:29] offset:1024 sc1
    global_load_dwordx4 v[24:27], v14, s[28:29] offset:2048 sc1
    global_load_dwordx4 v[28:31], v14, s[28:29] offset:3072 sc1
    s_waitcnt vmcnt(0)
    v_xor_b32 v16, v136, v16
    v_xor_b32 v17, v137, v17
    v_xor_b32 v18, v138, v18
    v_xor_b32 v19, v139, v19
    v_xor_b32 v20, v136, v20
    v_xor_b32 v21, v137, v21
    v_xor_b32 v22, v138, v22
    v_xor_b32 v23, v139, v23
    v_xor_b32 v24, v136, v24
    v_xor_b32 v25, v137, v25
    v_xor_b32 v26, v138, v26
    v_xor_b32 v27, v139, v27
    v_xor_b32 v28, v136, v28
    v_xor_b32 v29, v137, v29
    v_xor_b32 v30, v138, v30
    v_xor_b32 v31, v139, v31
    v_or3_b32 v32, v16, v17, v18
    v_or3_b32 v32, v32, v19, v20
    v_or3_b32 v32, v32, v21, v22
    v_or3_b32 v32, v32, v23, v24
    v_or3_b32 v32, v32, v25, v26
    v_or3_b32 v32, v32, v27, v28
    v_or3_b32 v32, v32, v29, v30
    v_or_b32 v32, v32, v31
    v_and_b32 v32, 15, v32
    v_cmp_ne_u32 vcc, 0, v32
    s_cmp_gt_u32 s82, 65536
    s_cbranch_scc1 L_pq_q
    s_cbranch_vccnz L_pq_h
L_pq_q:
    v_add_f32 v16, v16, v20
    v_add_f32 v24, v24, v28
    v_add_f32 v17, v17, v21
    v_add_f32 v25, v25, v29
    v_add_f32 v18, v18, v22
    v_add_f32 v26, v26, v30
    v_add_f32 v19, v19, v23
    v_add_f32 v27, v27, v31
    v_add_f32 v16, v16, v24
    v_add_f32 v17, v17, v25
    v_add_f32 v18, v18, v26
    v_add_f32 v19, v19, v27
    v_cvt_pk_bf16_f32 v16, v16, v17
    v_cvt_pk_bf16_f32 v17, v18, v19
    ds_write_b64 v15, v[16:17] offset:1536
    ds_write_b32 v4, v150 offset:68
    s_mov_b32 s69, 1
L_pq_h:
    s_waitcnt vmcnt(0)
    s_add_u32 s82, s82, 1
    s_cmp_lg_u32 s68, 0
    s_cbranch_scc1 L_pq_m
    v_cmp_ne_u32 vcc, v33, v134
    s_mov_b32 s68, 2
    s_cbranch_vccz L_pq_m
    s_mov_b32 s68, 0
    s_cmp_lt_u32 s82, 6
    s_cbranch_scc1 L_pq_again
    v_add_u32 v140, 1310720, v140
    global_store_dwordx2 v141, v[128:129], s[28:29] sc1
    s_mov_b32 exec_lo, 0xff00ff
    s_mov_b32 exec_hi, 0xff00ff
    global_store_dwordx4 v140, v[112:115], s[28:29] sc1
    s_mov_b64 exec, -1
    s_mov_b32 s68, 1
    s_waitcnt vmcnt(0)
L_pq_m:
    s_cmp_lg_u32 s69, 0
    s_cbranch_scc1 L_pq_done
    s_cmp_eq_u32 s68, 1
    s_cselect_b32 s34, 1310720, 0
    s_xor_b32 s70, s70, s34
L_pq_again:
    s_sleep 4
    s_branch L_pq
L_pq_done:
    v_lshlrev_b32 v14, 2, v6
    v_lshlrev_b32 v13, 3, v6
    s_mov_b32 s82, 0
L_hs:
    ds_read_b32 v30, v4 offset:72
    s_add_u32 s82, s82, 1
    s_cmp_gt_u32 s82, 4194304
    s_cbranch_scc1 L_hs_done
    s_waitcnt lgkmcnt(0)
    v_cmp_eq_u32 vcc, 8, v30
    s_cbranch_vccnz L_hs_done
    s_sleep 1
    s_branch L_hs
L_hs_done:
    ds_read_b64 v[20:21], v13 offset:384
    s_mov_b32 s34, 0xffff
    s_movk_i32 s35, 0xff
    s_waitcnt lgkmcnt(0)
    v_mov_b32 v16, v20
    s_nop 1
    v_max_f32 v16, v16, v16 quad_perm:[1,0,3,2] row_mask:0xf bank_mask:0xf
    s_nop 1
    v_max_f32 v16, v16, v16 quad_perm:[2,3,0,1] row_mask:0xf bank_mask:0xf
    s_nop 1
    v_max_f32 v16, v16, v16 row_half_mirror row_mask:0xf bank_mask:0xf
    v_sub_f32 v20, v20, v16
    v_mul_f32 v20, 0x3fb8aa3b, v20
    v_exp_f32 v20, v20
    s_nop 0
    v_mul_f32 v18, v20, v21
    ds_write_b32 v14, v20 offset:128
    v_mov_b32 v19, s68
    ds_write_b32 v4, v19 offset:80
    v_add_f32 v18, v18, v18 quad_perm:[1,0,3,2] row_mask:0xf bank_mask:0xf
    s_nop 1
    v_add_f32 v18, v18, v18 quad_perm:[2,3,0,1] row_mask:0xf bank_mask:0xf
    s_nop 1
    v_add_f32 v18, v18, v18 row_half_mirror row_mask:0xf bank_mask:0xf
    v_bfe_u32 v26, v160, 8, 12
    v_or_b32 v26, s66, v26
    v_lshrrev_b32 v27, 20, v160
    v_or_b32 v27, s66, v27
    v_cmp_eq_u32 vcc, 0, v0
    s_nop 1
    v_cndmask_b32 v19, v27, v26, vcc
    v_bfi_b32 v16, s34, v19, v16
    v_bfi_b32 v17, s35, v160, v18
    s_mov_b64 exec, 0x101
    global_store_dwordx2 v142, v[16:17], s[28:29]
    s_cmp_eq_u32 s68, 2
    s_cbranch_scc1 L_stl
    v_add_u32 v142, 1310720, v142
    global_store_dwordx2 v142, v[16:17], s[28:29] sc1
L_stl:
    s_mov_b64 exec, -1
    s_cmpk_ge_u32 s2, 112
    s_cbranch_scc1 L_hmlp
    s_cmpk_ge_u32 s2, 72
    s_cbranch_scc1 L_hnone
    s_lshl_b32 s34, s61, 9
    s_add_u32 s34, s34, 131072
    v_lshrrev_b32 v14, 5, v0
    v_lshlrev_b32 v14, 8, v14
    v_lshl_add_u32 v14, v6, 4, v14
    v_add_u32 v14, s34, v14
    s_mov_b32 s82, 0
L_hp:
    ds_read_b32 v30, v4 offset:100
    s_add_u32 s82, s82, 1
    s_cmp_gt_u32 s82, 4194304
    s_cbranch_scc1 L_hp_done
    s_waitcnt lgkmcnt(0)
    v_cmp_eq_u32 vcc, 1, v30
    s_cbranch_vccnz L_hp_done
    s_sleep 1
    s_branch L_hp
L_hp_done:
    s_mov_b32 s82, 0
    s_mov_b32 s70, 0
    s_branch L_ps_go
L_ps_retry:
    s_add_u32 s82, s82, 1
    s_cmp_gt_u32 s82, 65536
    s_cbranch_scc1 L_ps_done
    s_sleep 4
    s_cmp_eq_u32 s68, 1
    s_cselect_b32 s34, 1310720, 0
    s_xor_b32 s70, s70, s34
L_ps_go:
    v_add_u32 v15, s70, v14
    s_cmp_eq_u32 s70, 0
    s_movk_i32 s35, 0xfff
    s_cselect_b32 s35, 0xffff, s35
    global_load_dwordx4 v[20:23], v15, s[28:29] sc1
    s_waitcnt vmcnt(0)
    v_bitop3_b32 v24, v21, v23, v160 bitop3:0x7e
    v_and_b32 v24, 0xff, v24
    v_bitop3_b32 v24, v24, v20, v26 bitop3:0xf6
    v_bitop3_b32 v24, v24, v22, v27 bitop3:0xf6
    v_and_b32 v24, s35, v24
    v_cmp_ne_u32 vcc, 0, v24
    s_cbranch_vccnz L_ps_retry
L_ps_done:
    s_cmp_eq_u32 s70, 0
    s_cselect_b32 s34, 2, 1
    s_mov_b32 vcc_lo, 0xffff0000
    s_mov_b32 vcc_hi, 0xffff0000
    v_cndmask_b32 v20, v20, v22, vcc
    v_cndmask_b32 v22, v21, v23, vcc
    v_and_b32 v20, 0xffff0000, v20
    v_and_b32 v22, 0xffffff00, v22
    v_mov_b32 v21, v20
    s_nop 1
    v_max_f32 v21, v21, v21 quad_perm:[1,0,3,2] row_mask:0xf bank_mask:0xf
    s_nop 1
    v_max_f32 v21, v21, v21 quad_perm:[2,3,0,1] row_mask:0xf bank_mask:0xf
    s_nop 1
    v_max_f32 v21, v21, v21 row_half_mirror row_mask:0xf bank_mask:0xf
    v_sub_f32 v20, v20, v21
    v_mul_f32 v20, 0x3fb8aa3b, v20
    v_exp_f32 v20, v20
    s_nop 0
    v_mul_f32 v21, v20, v22
    s_nop 1
    v_add_f32 v21, v21, v21 quad_perm:[1,0,3,2] row_mask:0xf bank_mask:0xf
    s_nop 1
    v_add_f32 v21, v21, v21 quad_perm:[2,3,0,1] row_mask:0xf bank_mask:0xf
    s_nop 1
    v_add_f32 v21, v21, v21 row_half_mirror row_mask:0xf bank_mask:0xf
    v_rcp_f32 v21, v21
    s_nop 0
    v_mul_f32 v20, v20, v21
    v_mov_b32 v21, s34
    ds_write_b32 v7, v20 offset:1024
    ds_write_b32 v4, v21 offset:104
    s_andn2_b32 s34, s62, 3
    s_add_u32 s34, s34, s62
    s_lshl_b32 s34, s34, 11
    s_lshl2_add_u32 s34, s61, s34
    s_add_u32 s34, s34, 409600
    v_lshl_add_u32 v80, v6, 7, s34
    v_bfe_u32 v92, v0, 2, 1
    v_xor_b32 v92, 0, v92
    v_lshl_add_u32 v80, v92, 13, v80
    s_mov_b32 s82, 0
L_hn0:
    ds_read_b32 v30, v4 offset:84
    s_add_u32 s82, s82, 1
    s_cmp_gt_u32 s82, 4194304
    s_cbranch_scc1 L_hn0_done
    s_waitcnt lgkmcnt(0)
    v_cmp_le_u32 vcc, 7, v30
    s_cbranch_vccnz L_hn0_done
    s_sleep 1
    s_branch L_hn0
L_hn0_done:
    s_mov_b64 exec, 0xffff
    s_mov_b32 s82, 0
L_hn:
    ds_read_b32 v30, v4 offset:92
    s_add_u32 s82, s82, 1
    s_cmp_gt_u32 s82, 4194304
    s_cbranch_scc1 L_hn_done
    s_waitcnt lgkmcnt(0)
    v_cmp_gt_u32 vcc, 8, v30
    s_cbranch_vccnz L_hn
L_hn_done:
    global_store_dword v80, v160, s[28:29] sc1
    s_branch L_fin
L_hnone:
    s_branch L_fin
L_hmlp:
    s_mul_i32 s34, s62, 36864
    s_lshl_b32 s35, s33, 7
    s_add_u32 s34, s34, s35
    s_add_u32 s44, s20, s34
    s_addc_u32 s45, s21, 0
    s_and_b32 s45, s45, 0xffff
    s_mov_b32 s46, 35840
    v_bfe_u32 v3, v0, 3, 2
    v_lshrrev_b32 v122, 5, v0
    v_lshl_add_u32 v3, v122, 3, v3
    v_mul_u32_u24 v3, 1152, v3
    v_add_u32 v3, v3, v120
    s_lshl_b32 s58, s33, 12
    s_add_u32 s58, s58, 75264
    s_and_b32 s35, s33, 3
    s_lshl2_add_u32 s34, s62, s35
    s_lshl_b32 s34, s34, 4
    v_and_b32 v122, 6, v0
    v_lshl_add_u32 v122, v122, 1, s34
    s_mul_i32 s34, s33, 294912
    s_lshl_b32 s35, s62, 6
    s_add_u32 s34, s34, s35
    s_add_u32 s36, s16, s34
    s_addc_u32 s37, s17, 0
    s_and_b32 s37, s37, 0xffff
    s_mov_b32 s38, 2939968
    v_lshrrev_b32 v126, 5, v0
    v_and_b32 v127, 3, v0
    v_xor_b32 v127, v126, v127
    v_lshrrev_b32 v126, 2, v0
    v_mul_u32_u24 v126, 9216, v126
    v_lshl_add_u32 v126, v127, 4, v126
    v_xor_b32 v127, 32, v126
    s_lshl_b32 s56, s33, 11
    s_add_u32 s56, s56, 112128
    v_bfe_u32 v101, v0, 3, 1
    v_and_b32 v102, 7, v0
    v_lshl_add_u32 v103, v5, 3, v102
    s_andn2_b32 s34, s33, 3
    s_add_u32 s34, s34, s33
    s_bfe_u32 s35, s2, 0x10002
    s_xor_b32 s35, s35, 0
    s_and_b32 s35, s35, 1
    s_lshl2_add_u32 s34, s35, s34
    s_lshl_b32 s34, s34, 11
    s_add_u32 s34, s34, 458752
    v_add_u32 v72, s34, v2
    s_lshl_b32 s34, s33, 7
    v_mul_u32_u24 v73, 1152, v101
    v_lshl_add_u32 v73, v102, 4, v73
    v_and_b32 v103, 1, v5
    v_lshl_add_u32 v73, v103, 3, v73
    v_add_u32 v73, s34, v73
    v_lshlrev_b32 v76, 3, v5
    v_lshlrev_b32 v75, 2, v101
    v_lshl_add_u32 v75, v5, 3, v75
    s_lshl_b32 s34, s33, 5
    v_add_u32 v74, s34, v75
    v_lshl_add_u32 v77, v102, 5, v75
    v_lshlrev_b32 v95, 3, v101
    s_lshr_b32 s34, s62, 4
    s_lshl_b32 s34, s34, 6
    s_and_b32 s35, s62, 7
    s_lshl3_add_u32 s34, s35, s34
    v_and_b32 v96, 1, v0
    v_lshlrev_b32 v96, 2, v96
    v_and_b32 v97, 1, v5
    v_lshl_add_u32 v96, v97, 1, v96
    v_lshrrev_b32 v97, 5, v0
    v_add3_u32 v96, v96, v97, s34
    v_lshlrev_b32 v96, 1, v96
    v_mov_b32 v98, 0
    global_load_short_d16_hi v98, v96, s[22:23]
    s_bfe_u32 s35, s62, 0x10003
    s_mul_i32 s35, s35, 1152
    v_add_u32 v96, s35, v96
    s_bfe_u32 s34, s62, 0x20001
    s_mul_i32 s34, s34, 172032
    s_add_u32 s34, s34, 589824
    s_add_u32 s40, s28, s34
    s_addc_u32 s41, s29, 0
    s_and_b32 s41, s41, 0xffff
    s_mov_b32 s42, 165888
    s_mov_b32 s43, 0x20000
    s_lshr_b32 s35, s62, 3
    s_and_b32 s34, s62, 1
    s_lshl1_add_u32 s34, s35, s34
    s_lshl_b32 s34, s34, 5
    v_lshrrev_b32 v97, 1, v0
    v_mul_u32_u24 v97, 1152, v97
    v_and_b32 v17, 1, v0
    v_lshl_add_u32 v97, v17, 4, v97
    v_add_u32 v97, s34, v97
    s_mov_b32 s68, 0
    s_mov_b32 s69, 36864
    s_mov_b32 s70, 73728
    s_mov_b32 s71, 110592
    s_mov_b32 s72, 147456
    s_andn2_b32 s34, s61, 63
    s_add_u32 s34, s34, s61
    s_bfe_u32 s35, s61, 0x10002
    s_xor_b32 s35, s35, 0
    s_lshl_b32 s35, s35, 6
    s_add_u32 s34, s34, s35
    s_lshl_b32 s34, s34, 7
    s_add_u32 s34, s34, 409600
    s_add_u32 s26, s28, s34
    s_addc_u32 s27, s29, 0
    s_load_dword s34, s[26:27], 0 glc
    s_waitcnt lgkmcnt(0)
    s_barrier
    s_add_u32 m0, s58, 0
    s_mov_b32 s83, 0
    buffer_load_dwordx4 v3, s[44:47], s83 offen nt lds
    s_branch L_mlp
L_stream_m:
    s_mul_i32 s34, s62, 36864
    s_lshl_b32 s35, s33, 7
    s_add_u32 s34, s34, s35
    s_add_u32 s44, s20, s34
    s_addc_u32 s45, s21, 0
    s_and_b32 s45, s45, 0xffff
    s_mov_b32 s46, 35840
    v_bfe_u32 v3, v0, 3, 2
    v_lshrrev_b32 v122, 5, v0
    v_lshl_add_u32 v3, v122, 3, v3
    v_mul_u32_u24 v3, 1152, v3
    v_add_u32 v3, v3, v120
    s_lshl_b32 s58, s33, 12
    s_add_u32 s58, s58, 75264
    s_and_b32 s35, s33, 3
    s_lshl2_add_u32 s34, s62, s35
    s_lshl_b32 s34, s34, 4
    v_and_b32 v122, 6, v0
    v_lshl_add_u32 v122, v122, 1, s34
    v_mul_u32_u24 v124, 7282, v0
    v_lshrrev_b32 v124, 16, v124
    v_mul_u32_u24 v125, 9, v124
    v_sub_u32 v125, v0, v125
    s_and_b32 s35, s2, 7
    s_mul_i32 s35, s35, 9
    v_add_lshl_u32 v125, v125, s35, 7
    s_lshr_b32 s34, s2, 3
    s_sub_u32 s34, s34, 14
    s_lshl3_add_u32 s34, s34, s33
    s_mul_i32 s34, s34, 2
    v_add_u32 v124, s34, v124
    s_waitcnt vmcnt(3)
    s_add_u32 m0, s57, 2080
    s_xor_b32 s83, s60, 8192
    buffer_load_dwordx4 v1, s[36:39], s83 offen nt lds
    s_waitcnt vmcnt(3)
    s_add_u32 m0, s57, 3120
    s_xor_b32 s83, s60, 12288
    buffer_load_dwordx4 v1, s[36:39], s83 offen nt lds
    global_load_dword v123, v122, s[18:19]
    s_waitcnt vmcnt(3)
    s_add_u32 m0, s57, 4160
    s_xor_b32 s83, s60, 16384
    buffer_load_dwordx4 v1, s[36:39], s83 offen nt lds
    s_mov_b64 exec, 1
    ds_add_u32 v4, v121 offset:64
    s_mov_b64 exec, -1
    s_waitcnt vmcnt(3)
    s_add_u32 m0, s57, 5200
    s_xor_b32 s83, s60, 20480
    buffer_load_dwordx4 v1, s[36:39], s83 offen nt lds
    s_waitcnt vmcnt(3)
    s_add_u32 m0, s57, 6240
    s_xor_b32 s83, s60, 24576
    buffer_load_dwordx4 v1, s[36:39], s83 offen nt lds
    ds_read_b128 v[8:11], v152 offset:0
    ds_read_b128 v[12:15], v153 offset:0
    ds_read_b128 v[16:19], v154 offset:0
    ds_read_b128 v[20:23], v155 offset:0
    s_waitcnt vmcnt(3)
    s_add_u32 m0, s57, 7280
    s_xor_b32 s83, s60, 28672
    buffer_load_dwordx4 v1, s[36:39], s83 offen nt lds
    s_waitcnt vmcnt(2)
    s_waitcnt lgkmcnt(0)
    s_add_u32 m0, s57, 0
    s_xor_b32 s83, s60, 131072
    buffer_load_dwordx4 v1, s[36:39], s83 offen nt lds
    s_waitcnt vmcnt(2)
    s_add_u32 m0, s57, 1040
    s_xor_b32 s83, s60, 135168
    buffer_load_dwordx4 v1, s[36:39], s83 offen nt lds
    s_waitcnt vmcnt(2)
    s_add_u32 m0, s57, 2080
    s_xor_b32 s83, s60, 139264
    buffer_load_dwordx4 v1, s[36:39], s83 offen nt lds
    ds_read_b128 v[24:27], v152 offset:4160
    ds_read_b128 v[28:31], v153 offset:4160
    ds_read_b128 v[32:35], v154 offset:4160
    ds_read_b128 v[36:39], v155 offset:4160
    s_waitcnt vmcnt(2)
    s_add_u32 m0, s57, 3120
    s_xor_b32 s83, s60, 143360
    buffer_load_dwordx4 v1, s[36:39], s83 offen nt lds
    s_waitcnt vmcnt(2)
    s_waitcnt lgkmcnt(0)
    s_add_u32 m0, s57, 4160
    s_xor_b32 s83, s60, 147456
    buffer_load_dwordx4 v1, s[36:39], s83 offen nt lds
    s_waitcnt vmcnt(2)
    s_add_u32 m0, s57, 5200
    s_xor_b32 s83, s60, 151552
    buffer_load_dwordx4 v1, s[36:39], s83 offen nt lds
    s_waitcnt vmcnt(2)
    s_add_u32 m0, s57, 6240
    s_xor_b32 s83, s60, 155648
    buffer_load_dwordx4 v1, s[36:39], s83 offen nt lds
    ds_read_b128 v[40:43], v152 offset:0
    ds_read_b128 v[44:47], v153 offset:0
    ds_read_b128 v[48:51], v154 offset:0
    ds_read_b128 v[52:55], v155 offset:0
    s_waitcnt vmcnt(2)
    s_add_u32 m0, s57, 7280
    s_xor_b32 s83, s60, 159744
    buffer_load_dwordx4 v1, s[36:39], s83 offen nt lds
    s_waitcnt vmcnt(2)
    s_xor_b32 s83, s60, 0
    buffer_load_dwordx4 v[72:75], v2, s[40:43], s83 offen nt
    s_waitcnt vmcnt(2)
    s_xor_b32 s83, s60, 4096
    buffer_load_dwordx4 v[76:79], v2, s[40:43], s83 offen nt
    s_waitcnt vmcnt(2)
    s_xor_b32 s83, s60, 8192
    buffer_load_dwordx4 v[80:83], v2, s[40:43], s83 offen nt
    ds_read_b128 v[56:59], v152 offset:4160
    ds_read_b128 v[60:63], v153 offset:4160
    ds_read_b128 v[64:67], v154 offset:4160
    ds_read_b128 v[68:71], v155 offset:4160
    s_waitcnt vmcnt(2)
    s_xor_b32 s83, s60, 12288
    buffer_load_dwordx4 v[84:87], v2, s[40:43], s83 offen nt
    s_mov_b32 s82, 0
L_sqm:
    ds_read_b32 v152, v4 offset:68
    s_add_u32 s82, s82, 1
    s_cmp_gt_u32 s82, 4194304
    s_cbranch_scc1 L_sqm_done
    s_waitcnt lgkmcnt(0)
    v_cmp_eq_u32 vcc, 1, v152
    s_cbranch_vccnz L_sqm_done
    s_sleep 1
    s_branch L_sqm
L_sqm_done:
    ds_read_b128 v[136:139], v7 offset:1536
    ds_read_b128 v[140:143], v7 offset:1600
    ds_read_b128 v[144:147], v7 offset:1664
    ds_read_b128 v[148:151], v7 offset:1728
    s_waitcnt lgkmcnt(0)
    v_mfma_f32_16x16x32_bf16 v[152:155], v[8:11], v[136:139], 0
    v_mfma_f32_16x16x32_bf16 v[156:159], v[24:27], v[136:139], 0
    v_mfma_f32_16x16x32_bf16 v[160:163], v[40:43], v[136:139], 0
    v_mfma_f32_16x16x32_bf16 v[164:167], v[56:59], v[136:139], 0
    v_mfma_f32_16x16x32_bf16 v[152:155], v[12:15], v[140:143], v[152:155]
    v_mfma_f32_16x16x32_bf16 v[156:159], v[28:31], v[140:143], v[156:159]
    v_mfma_f32_16x16x32_bf16 v[160:163], v[44:47], v[140:143], v[160:163]
    v_mfma_f32_16x16x32_bf16 v[164:167], v[60:63], v[140:143], v[164:167]
    v_mfma_f32_16x16x32_bf16 v[152:155], v[16:19], v[144:147], v[152:155]
    v_mfma_f32_16x16x32_bf16 v[156:159], v[32:35], v[144:147], v[156:159]
    v_mfma_f32_16x16x32_bf16 v[160:163], v[48:51], v[144:147], v[160:163]
    v_mfma_f32_16x16x32_bf16 v[164:167], v[64:67], v[144:147], v[164:167]
    v_mfma_f32_16x16x32_bf16 v[152:155], v[20:23], v[148:151], v[152:155]
    v_mfma_f32_16x16x32_bf16 v[156:159], v[36:39], v[148:151], v[156:159]
    v_mfma_f32_16x16x32_bf16 v[160:163], v[52:55], v[148:151], v[160:163]
    v_mfma_f32_16x16x32_bf16 v[164:167], v[68:71], v[148:151], v[164:167]
    s_waitcnt vmcnt(2)
    s_xor_b32 s83, s60, 16384
    buffer_load_dwordx4 v[88:91], v2, s[40:43], s83 offen nt
    s_mov_b32 s34, 0x3db504f3
    s_lshl_b32 s35, s33, 3
    v_lshl_add_u32 v7, v0, 6, s35
    v_cvt_pk_bf16_f32 v152, 0, v152
    v_cvt_pk_bf16_f32 v153, 0, v153
    v_cvt_pk_bf16_f32 v154, 0, v154
    v_cvt_pk_bf16_f32 v155, 0, v155
    v_cvt_pk_bf16_f32 v156, 0, v156
    v_cvt_pk_bf16_f32 v157, 0, v157
    v_cvt_pk_bf16_f32 v158, 0, v158
    v_cvt_pk_bf16_f32 v159, 0, v159
    v_cvt_pk_bf16_f32 v160, 0, v160
    v_cvt_pk_bf16_f32 v161, 0, v161
    v_cvt_pk_bf16_f32 v162, 0, v162
    v_cvt_pk_bf16_f32 v163, 0, v163
    v_cvt_pk_bf16_f32 v164, 0, v164
    v_cvt_pk_bf16_f32 v165, 0, v165
    v_cvt_pk_bf16_f32 v166, 0, v166
    v_cvt_pk_bf16_f32 v167, 0, v167
    v_mul_f32 v152, s34, v152
    v_mul_f32 v153, s34, v153
    v_mul_f32 v154, s34, v154
    v_mul_f32 v155, s34, v155
    v_mul_f32 v156, s34, v156
    v_mul_f32 v157, s34, v157
    v_mul_f32 v158, s34, v158
    v_mul_f32 v159, s34, v159
    v_mul_f32 v160, s34, v160
    v_mul_f32 v161, s34, v161
    v_mul_f32 v162, s34, v162
    v_mul_f32 v163, s34, v163
    v_mul_f32 v164, s34, v164
    v_mul_f32 v165, s34, v165
    v_mul_f32 v166, s34, v166
    v_mul_f32 v167, s34, v167
    v_cvt_pk_bf16_f32 v152, 0, v152
    v_cvt_pk_bf16_f32 v153, 0, v153
    v_cvt_pk_bf16_f32 v154, 0, v154
    v_cvt_pk_bf16_f32 v155, 0, v155
    v_cvt_pk_bf16_f32 v156, 0, v156
    v_cvt_pk_bf16_f32 v157, 0, v157
    v_cvt_pk_bf16_f32 v158, 0, v158
    v_cvt_pk_bf16_f32 v159, 0, v159
    v_cvt_pk_bf16_f32 v160, 0, v160
    v_cvt_pk_bf16_f32 v161, 0, v161
    v_cvt_pk_bf16_f32 v162, 0, v162
    v_cvt_pk_bf16_f32 v163, 0, v163
    v_cvt_pk_bf16_f32 v164, 0, v164
    v_cvt_pk_bf16_f32 v165, 0, v165
    v_cvt_pk_bf16_f32 v166, 0, v166
    v_cvt_pk_bf16_f32 v167, 0, v167
    v_max3_f32 v148, v152, v153, v154
    v_max3_f32 v148, v148, v155, v156
    v_max3_f32 v148, v148, v157, v158
    v_max3_f32 v148, v148, v159, v160
    v_max3_f32 v148, v148, v161, v162
    v_max3_f32 v148, v148, v163, v164
    v_max3_f32 v148, v148, v165, v166
    v_max_f32 v148, v148, v167
    v_mov_b32 v149, v148
    s_nop 1
    v_permlane16_swap_b32 v148, v149
    v_max_f32 v148, v148, v149
    v_mov_b32 v149, v148
    s_nop 1
    v_permlane32_swap_b32 v148, v149
    v_max_f32 v148, v148, v149
    s_waitcnt vmcnt(2)
    s_xor_b32 s83, s60, 20480
    buffer_load_dwordx4 v[92:95], v2, s[40:43], s83 offen nt
    s_mov_b32 s34, 0x3fb8aa3b
    v_sub_f32 v152, v152, v148
    v_sub_f32 v153, v153, v148
    v_sub_f32 v154, v154, v148
    v_sub_f32 v155, v155, v148
    v_sub_f32 v156, v156, v148
    v_sub_f32 v157, v157, v148
    v_sub_f32 v158, v158, v148
    v_sub_f32 v159, v159, v148
    v_sub_f32 v160, v160, v148
    v_sub_f32 v161, v161, v148
    v_sub_f32 v162, v162, v148
    v_sub_f32 v163, v163, v148
    v_sub_f32 v164, v164, v148
    v_sub_f32 v165, v165, v148
    v_sub_f32 v166, v166, v148
    v_sub_f32 v167, v167, v148
    v_mul_f32 v152, s34, v152
    v_mul_f32 v153, s34, v153
    v_mul_f32 v154, s34, v154
    v_mul_f32 v155, s34, v155
    v_mul_f32 v156, s34, v156
    v_mul_f32 v157, s34, v157
    v_mul_f32 v158, s34, v158
    v_mul_f32 v159, s34, v159
    v_mul_f32 v160, s34, v160
    v_mul_f32 v161, s34, v161
    v_mul_f32 v162, s34, v162
    v_mul_f32 v163, s34, v163
    v_mul_f32 v164, s34, v164
    v_mul_f32 v165, s34, v165
    v_mul_f32 v166, s34, v166
    v_mul_f32 v167, s34, v167
    v_exp_f32 v152, v152
    v_exp_f32 v153, v153
    v_exp_f32 v154, v154
    v_exp_f32 v155, v155
    v_exp_f32 v156, v156
    v_exp_f32 v157, v157
    v_exp_f32 v158, v158
    v_exp_f32 v159, v159
    v_exp_f32 v160, v160
    v_exp_f32 v161, v161
    v_exp_f32 v162, v162
    v_exp_f32 v163, v163
    v_exp_f32 v164, v164
    v_exp_f32 v165, v165
    v_exp_f32 v166, v166
    v_exp_f32 v167, v167
    v_cvt_pk_bf16_f32 v56, v152, v152
    v_cvt_pk_bf16_f32 v57, v153, v153
    v_cvt_pk_bf16_f32 v58, v154, v154
    v_cvt_pk_bf16_f32 v59, v155, v155
    v_cvt_pk_bf16_f32 v60, v156, v156
    v_cvt_pk_bf16_f32 v61, v157, v157
    v_cvt_pk_bf16_f32 v62, v158, v158
    v_cvt_pk_bf16_f32 v63, v159, v159
    v_cvt_pk_bf16_f32 v64, v160, v160
    v_cvt_pk_bf16_f32 v65, v161, v161
    v_cvt_pk_bf16_f32 v66, v162, v162
    v_cvt_pk_bf16_f32 v67, v163, v163
    v_cvt_pk_bf16_f32 v68, v164, v164
    v_cvt_pk_bf16_f32 v69, v165, v165
    v_cvt_pk_bf16_f32 v70, v166, v166
    v_cvt_pk_bf16_f32 v71, v167, v167
    v_add_f32 v152, v152, v160
    v_add_f32 v153, v153, v161
    v_add_f32 v154, v154, v162
    v_add_f32 v155, v155, v163
    v_add_f32 v156, v156, v164
    v_add_f32 v157, v157, v165
    v_add_f32 v158, v158, v166
    v_add_f32 v159, v159, v167
    v_add_f32 v152, v152, v156
    v_add_f32 v153, v153, v157
    v_add_f32 v154, v154, v158
    v_add_f32 v155, v155, v159
    v_add_f32 v152, v152, v154
    v_add_f32 v153, v153, v155
    v_add_f32 v149, v152, v153
    v_mov_b32 v150, v149
    s_nop 1
    v_permlane16_swap_b32 v149, v150
    v_add_f32 v149, v149, v150
    v_mov_b32 v150, v149
    s_nop 1
    v_permlane32_swap_b32 v149, v150
    v_add_f32 v149, v149, v150
    v_mov_b32 v150, 1
    s_mov_b64 exec, 3
    ds_write_b64 v7, v[148:149] offset:384
    s_mov_b64 exec, 1
    ds_add_u32 v4, v150 offset:72
    s_mov_b64 exec, -1
    s_waitcnt vmcnt(2)
    s_xor_b32 s83, s60, 24576
    buffer_load_dwordx4 v[96:99], v2, s[40:43], s83 offen nt
    v_add_u32 v7, s57, v2
    v_add_u32 v148, 8704, v2
    s_lshl3_add_u32 s35, s31, s32
    s_lshl_b32 s34, s30, 5
    s_add_u32 s34, s34, s35
    s_lshl_b32 s34, s34, 8
    s_add_u32 s34, s34, 139264
    v_and_b32 v157, 1, v0
    v_lshlrev_b32 v161, 12, v157
    v_lshrrev_b32 v158, 1, v0
    v_lshl_add_u32 v149, v158, 3, v161
    v_add_u32 v149, s34, v149
    s_lshl_b32 s34, s30, 13
    s_lshl4_add_u32 s34, s35, s34
    s_add_u32 s34, s34, 270336
    v_lshrrev_b32 v158, 2, v0
    v_lshl_add_u32 v161, v158, 8, v161
    v_and_b32 v158, 2, v0
    v_lshl_add_u32 v161, v158, 2, v161
    v_add_u32 v161, s34, v161
    s_lshl_b32 s34, s33, 2
    v_lshl_add_u32 v157, v157, 5, s34
    v_mov_b32 v140, 0xffff
    v_mov_b32 v141, 0xffff0000
    v_cndmask_b32_e64 v136, 0, v140, s[64:65]
    v_cndmask_b32_e64 v136, v136, v141, s[66:67]
    v_cndmask_b32_e64 v137, 0, v140, s[68:69]
    v_cndmask_b32_e64 v137, v137, v141, s[70:71]
    v_cndmask_b32_e64 v138, 0, v140, s[72:73]
    v_cndmask_b32_e64 v138, v138, v141, s[74:75]
    v_cndmask_b32_e64 v139, 0, v140, s[76:77]
    v_cndmask_b32_e64 v139, v139, v141, s[78:79]
    v_and_b32 v40, v136, v56
    v_and_b32 v41, v137, v56
    v_and_b32 v42, v138, v56
    v_and_b32 v43, v139, v56
    s_nop 1
    v_mfma_f32_16x16x32_bf16 v[144:147], v[72:75], v[40:43], 0
    v_and_b32 v44, v136, v57
    v_and_b32 v45, v137, v57
    v_and_b32 v46, v138, v57
    v_and_b32 v47, v139, v57
    s_nop 1
    v_mfma_f32_16x16x32_bf16 v[144:147], v[76:79], v[44:47], v[144:147]
    v_and_b32 v48, v136, v58
    v_and_b32 v49, v137, v58
    v_and_b32 v50, v138, v58
    v_and_b32 v51, v139, v58
    s_nop 1
    v_mfma_f32_16x16x32_bf16 v[144:147], v[80:83], v[48:51], v[144:147]
    v_and_b32 v52, v136, v59
    v_and_b32 v53, v137, v59
    v_and_b32 v54, v138, v59
    v_and_b32 v55, v139, v59
    s_nop 1
    v_mfma_f32_16x16x32_bf16 v[144:147], v[84:87], v[52:55], v[144:147]
    v_and_b32 v40, v136, v60
    v_and_b32 v41, v137, v60
    v_and_b32 v42, v138, v60
    v_and_b32 v43, v139, v60
    s_waitcnt vmcnt(2)
    s_xor_b32 s83, s60, 28672
    buffer_load_dwordx4 v[100:103], v2, s[40:43], s83 offen nt
    v_mfma_f32_16x16x32_bf16 v[144:147], v[88:91], v[40:43], v[144:147]
    v_and_b32 v44, v136, v61
    v_and_b32 v45, v137, v61
    v_and_b32 v46, v138, v61
    v_and_b32 v47, v139, v61
    s_waitcnt vmcnt(2)
    s_xor_b32 s83, s60, 131072
    buffer_load_dwordx4 v[104:107], v2, s[40:43], s83 offen nt
    v_mfma_f32_16x16x32_bf16 v[144:147], v[92:95], v[44:47], v[144:147]
    v_and_b32 v48, v136, v62
    v_and_b32 v49, v137, v62
    v_and_b32 v50, v138, v62
    v_and_b32 v51, v139, v62
    s_waitcnt vmcnt(2)
    s_xor_b32 s83, s60, 135168
    buffer_load_dwordx4 v[108:111], v2, s[40:43], s83 offen nt
    v_mfma_f32_16x16x32_bf16 v[144:147], v[96:99], v[48:51], v[144:147]
    v_and_b32 v52, v136, v63
    v_and_b32 v53, v137, v63
    v_and_b32 v54, v138, v63
    v_and_b32 v55, v139, v63
    s_waitcnt vmcnt(2)
    s_xor_b32 s83, s60, 139264
    buffer_load_dwordx4 v[112:115], v2, s[40:43], s83 offen nt
    v_mfma_f32_16x16x32_bf16 v[144:147], v[100:103], v[52:55], v[144:147]
    v_and_b32 v40, v136, v64
    v_and_b32 v41, v137, v64
    v_and_b32 v42, v138, v64
    v_and_b32 v43, v139, v64
    s_waitcnt vmcnt(2)
    s_xor_b32 s83, s60, 143360
    buffer_load_dwordx4 v[116:119], v2, s[40:43], s83 offen nt
    v_mfma_f32_16x16x32_bf16 v[144:147], v[104:107], v[40:43], v[144:147]
    v_and_b32 v44, v136, v65
    v_and_b32 v45, v137, v65
    v_and_b32 v46, v138, v65
    v_and_b32 v47, v139, v65
    s_waitcnt vmcnt(2)
    s_xor_b32 s83, s60, 147456
    buffer_load_dwordx4 v[24:27], v2, s[40:43], s83 offen nt
    v_mfma_f32_16x16x32_bf16 v[144:147], v[108:111], v[44:47], v[144:147]
    s_mul_i32 s34, s33, 294912
    s_lshl_b32 s35, s62, 6
    s_add_u32 s34, s34, s35
    s_add_u32 s36, s16, s34
    s_addc_u32 s37, s17, 0
    s_and_b32 s37, s37, 0xffff
    s_mov_b32 s38, 2939968
    v_lshrrev_b32 v126, 5, v0
    v_and_b32 v127, 3, v0
    v_xor_b32 v127, v126, v127
    v_lshrrev_b32 v126, 2, v0
    v_mul_u32_u24 v126, 9216, v126
    v_lshl_add_u32 v126, v127, 4, v126
    v_xor_b32 v127, 32, v126
    s_lshl_b32 s56, s33, 11
    s_add_u32 s56, s56, 112128
    v_bfe_u32 v101, v0, 3, 1
    v_and_b32 v102, 7, v0
    v_lshl_add_u32 v103, v5, 3, v102
    s_andn2_b32 s34, s33, 3
    s_add_u32 s34, s34, s33
    s_bfe_u32 s35, s2, 0x10002
    s_xor_b32 s35, s35, 0
    s_and_b32 s35, s35, 1
    s_lshl2_add_u32 s34, s35, s34
    s_lshl_b32 s34, s34, 11
    s_add_u32 s34, s34, 458752
    v_add_u32 v72, s34, v2
    s_lshl_b32 s34, s33, 7
    v_mul_u32_u24 v73, 1152, v101
    v_lshl_add_u32 v73, v102, 4, v73
    v_and_b32 v103, 1, v5
    v_lshl_add_u32 v73, v103, 3, v73
    v_add_u32 v73, s34, v73
    v_lshlrev_b32 v76, 3, v5
    v_lshlrev_b32 v75, 2, v101
    v_lshl_add_u32 v75, v5, 3, v75
    s_lshl_b32 s34, s33, 5
    v_add_u32 v74, s34, v75
    v_lshl_add_u32 v77, v102, 5, v75
    s_cmp_ge_u32 s33, 4
    s_cbranch_scc1 L_prep2
    v_lshlrev_b32 v97, 3, v101
    v_and_b32 v78, 1, v0
    v_mul_u32_u24 v78, 1152, v78
    v_bfe_u32 v82, v0, 1, 1
    v_mul_u32_u24 v79, 576, v82
    v_lshlrev_b32 v80, 4, v5
    v_add3_u32 v78, v78, v79, v80
    s_lshl_b32 s34, s33, 4
    v_lshlrev_b32 v79, 6, v101
    v_lshl_add_u32 v79, v102, 1, v79
    v_add_u32 v79, s34, v79
    v_mul_u32_u24 v80, 18432, v82
    v_lshl_add_u32 v80, v5, 9, v80
    v_bfe_u32 v83, v0, 2, 2
    v_lshl_add_u32 v80, v83, 6, v80
    v_and_b32 v83, 1, v5
    v_lshl_add_u32 v83, v82, 1, v83
    v_xor_b32 v83, s33, v83
    v_lshl_add_u32 v80, v83, 4, v80
    v_and_b32 v83, 1, v0
    v_lshl_add_u32 v80, v83, 3, v80
    v_add_u32 v80, 112128, v80
    v_mov_b32 v84, 0x3f803f80
    v_mov_b32 v85, 0x3f803f80
    v_mov_b32 v86, 0x3f803f80
    v_mov_b32 v87, 0x3f803f80
    v_lshlrev_b32 v81, 4, v83
    v_lshrrev_b32 v81, v81, v123
    v_lshlrev_b32 v81, 16, v81
    s_branch L_prepd
L_prep2:
    s_and_b32 s35, s33, 3
    s_lshl_b32 s34, s35, 5
    v_lshrrev_b32 v83, 2, v0
    v_lshlrev_b32 v80, 7, v83
    v_bfe_u32 v83, v0, 3, 2
    v_lshl_add_u32 v80, v83, 5, v80
    v_xor_b32 v80, s34, v80
    v_and_b32 v83, 3, v0
    v_lshl_add_u32 v80, v83, 3, v80
    v_add_u32 v80, 75264, v80
    v_and_b32 v83, 1, v0
    v_lshlrev_b32 v83, 6, v83
    v_lshl_add_u32 v83, v5, 4, v83
    v_add_u32 v83, 256, v83
    v_mov_b32 v82, 240
    v_cndmask_b32_e64 v88, v82, v83, s[64:65]
    v_cndmask_b32_e64 v89, v82, v83, s[66:67]
    v_cndmask_b32_e64 v90, v82, v83, s[68:69]
    v_cndmask_b32_e64 v91, v82, v83, s[70:71]
    v_cndmask_b32_e64 v92, v82, v83, s[72:73]
    v_cndmask_b32_e64 v93, v82, v83, s[74:75]
    v_cndmask_b32_e64 v94, v82, v83, s[76:77]
    v_cndmask_b32_e64 v95, v82, v83, s[78:79]
    s_mul_i32 s34, s61, 1152
    s_mul_i32 s35, s35, 172032
    s_add_u32 s34, s34, s35
    s_add_u32 s34, s34, 589824
    v_lshlrev_b32 v77, 6, v6
    v_lshl_add_u32 v77, v5, 4, v77
    v_add_u32 v77, s34, v77
L_prepd:
    v_and_b32 v48, v136, v66
    v_and_b32 v49, v137, v66
    v_and_b32 v50, v138, v66
    v_and_b32 v51, v139, v66
    s_waitcnt vmcnt(2)
    s_xor_b32 s83, s60, 151552
    buffer_load_dwordx4 v[28:31], v2, s[40:43], s83 offen nt
    v_mfma_f32_16x16x32_bf16 v[144:147], v[112:115], v[48:51], v[144:147]
    v_and_b32 v52, v136, v67
    v_and_b32 v53, v137, v67
    v_and_b32 v54, v138, v67
    v_and_b32 v55, v139, v67
    s_waitcnt vmcnt(2)
    s_xor_b32 s83, s60, 155648
    buffer_load_dwordx4 v[32:35], v2, s[40:43], s83 offen nt
    v_mfma_f32_16x16x32_bf16 v[144:147], v[116:119], v[52:55], v[144:147]
    v_and_b32 v40, v136, v68
    v_and_b32 v41, v137, v68
    v_and_b32 v42, v138, v68
    v_and_b32 v43, v139, v68
    s_waitcnt vmcnt(2)
    s_xor_b32 s83, s60, 159744
    buffer_load_dwordx4 v[36:39], v2, s[40:43], s83 offen nt
    s_barrier
    v_mfma_f32_16x16x32_bf16 v[144:147], v[24:27], v[40:43], v[144:147]
    v_and_b32 v44, v136, v69
    v_and_b32 v45, v137, v69
    v_and_b32 v46, v138, v69
    v_and_b32 v47, v139, v69
    v_min_u32 v128, 575, v124
    v_mul_u32_u24 v128, 9216, v128
    v_add_u32 v128, v128, v125
    s_mov_b64 exec, 0x1ff
    global_load_dword v129, v128, s[16:17]
    s_mov_b64 exec, -1
    v_add_u32 v124, 1, v124
    s_waitcnt vmcnt(3)
    v_min_u32 v128, 575, v124
    v_mul_u32_u24 v128, 9216, v128
    v_add_u32 v128, v128, v125
    s_mov_b64 exec, 0x1ff
    global_load_dword v129, v128, s[16:17]
    s_mov_b64 exec, -1
    v_add_u32 v124, 1, v124
    v_mfma_f32_16x16x32_bf16 v[144:147], v[28:31], v[44:47], v[144:147]
    v_and_b32 v48, v136, v70
    v_and_b32 v49, v137, v70
    v_and_b32 v50, v138, v70
    v_and_b32 v51, v139, v70
    s_mov_b32 s82, 0
L_sfm:
    ds_read_b32 v158, v4 offset:80
    s_add_u32 s82, s82, 1
    s_cmp_gt_u32 s82, 4194304
    s_cbranch_scc1 L_sfm_done
    s_waitcnt lgkmcnt(0)
    v_cmp_ne_u32 vcc, 0, v158
    s_cbranch_vccnz L_sfm_done
    s_sleep 1
    s_branch L_sfm
L_sfm_done:
    v_readfirstlane_b32 s54, v158
    ds_read_b32 v158, v157 offset:128
    ds_read_b32 v160, v4 offset:76
    s_waitcnt vmcnt(3)
    s_add_u32 m0, s58, 0
    s_mov_b32 s83, 0
    buffer_load_dwordx4 v3, s[44:47], s83 offen nt lds
    v_mfma_f32_16x16x32_bf16 v[144:147], v[32:35], v[48:51], v[144:147]
    v_and_b32 v52, v136, v71
    v_and_b32 v53, v137, v71
    v_and_b32 v54, v138, v71
    v_and_b32 v55, v139, v71
    s_waitcnt lgkmcnt(0)
    s_waitcnt vmcnt(3)
    v_mfma_f32_16x16x32_bf16 v[144:147], v[36:39], v[52:55], v[144:147]
    ds_read2_b32 v[152:153], v4 offset0:26 offset1:21
    s_nop 6
    v_pk_mul_f32 v[144:145], v[144:145], v[158:159] op_sel_hi:[1,0]
    v_pk_mul_f32 v[146:147], v[146:147], v[158:159] op_sel_hi:[1,0]
    ds_write_b128 v7, v[144:147]
    s_mov_b64 exec, 1
    ds_add_rtn_u32 v159, v4, v150 offset:84
    s_mov_b64 exec, -1
    ds_read_b128 v[8:11], v148 offset:0
    ds_read_b128 v[12:15], v148 offset:8320
    ds_read_b128 v[16:19], v148 offset:16640
    ds_read_b128 v[20:23], v148 offset:24960
    ds_read_b128 v[24:27], v148 offset:33280
    ds_read_b128 v[28:31], v148 offset:41600
    ds_read_b128 v[32:35], v148 offset:49920
    ds_read_b128 v[36:39], v148 offset:58240
    s_waitcnt lgkmcnt(8)
    v_readfirstlane_b32 s34, v159
    v_readfirstlane_b32 s63, v152
    s_cmp_eq_u32 s34, 7
    s_cbranch_scc0 L_noredm
L_redm:
    s_waitcnt lgkmcnt(6)
    v_pk_add_f32 v[8:9], v[8:9], v[12:13]
    v_pk_add_f32 v[10:11], v[10:11], v[14:15]
    s_waitcnt lgkmcnt(5)
    v_pk_add_f32 v[8:9], v[8:9], v[16:17]
    v_pk_add_f32 v[10:11], v[10:11], v[18:19]
    s_waitcnt lgkmcnt(4)
    v_pk_add_f32 v[8:9], v[8:9], v[20:21]
    v_pk_add_f32 v[10:11], v[10:11], v[22:23]
    s_waitcnt lgkmcnt(3)
    v_pk_add_f32 v[8:9], v[8:9], v[24:25]
    v_pk_add_f32 v[10:11], v[10:11], v[26:27]
    s_waitcnt lgkmcnt(2)
    v_pk_add_f32 v[8:9], v[8:9], v[28:29]
    v_pk_add_f32 v[10:11], v[10:11], v[30:31]
    s_waitcnt lgkmcnt(1)
    v_pk_add_f32 v[8:9], v[8:9], v[32:33]
    v_pk_add_f32 v[10:11], v[10:11], v[34:35]
    s_waitcnt lgkmcnt(0)
    v_pk_add_f32 v[8:9], v[8:9], v[36:37]
    v_pk_add_f32 v[10:11], v[10:11], v[38:39]
    v_cvt_pk_bf16_f32 v8, v8, v9
    v_cvt_pk_bf16_f32 v9, v10, v11
    global_store_dwordx2 v161, v[8:9], s[28:29]
    s_cmp_eq_u32 s54, 2
    s_cbranch_scc1 L_noredm
    global_store_dwordx2 v149, v[8:9], s[28:29] sc1
L_noredm:
L_mlp:
    s_barrier
    s_add_u32 m0, s58, 1024
    s_mov_b32 s83, 18432
    buffer_load_dwordx4 v3, s[44:47], s83 offen nt lds
    s_add_u32 m0, s58, 2048
    s_mov_b32 s83, 4608
    buffer_load_dwordx4 v3, s[44:47], s83 offen nt lds
    s_add_u32 m0, s58, 3072
    s_mov_b32 s83, 23040
    buffer_load_dwordx4 v3, s[44:47], s83 offen nt lds
    s_barrier
    s_add_u32 m0, s56, 0
    s_mov_b32 s83, 0
    buffer_load_dwordx4 v126, s[36:39], s83 offen  lds
    s_add_u32 m0, s56, 1024
    s_mov_b32 s83, 147456
    buffer_load_dwordx4 v126, s[36:39], s83 offen  lds
    s_add_u32 m0, s56, 18432
    s_mov_b32 s83, 2654208
    buffer_load_dwordx4 v127, s[36:39], s83 offen  lds
    s_add_u32 m0, s56, 19456
    s_mov_b32 s83, 2801664
    buffer_load_dwordx4 v127, s[36:39], s83 offen  lds
    s_mov_b32 s64, 0x01010101
    s_mov_b32 s65, s64
    s_movk_i32 s66, 0x3ff
    v_and_b32 v156, 1, v0
    v_lshlrev_b32 v156, 4, v156
    v_add_u32 v157, 8, v156
    v_min_u32 v157, 22, v157
    v_bfe_u32 v152, v160, v156, 10
    v_bfe_u32 v153, v160, v157, 10
    v_cmp_gt_u32 vcc, 32, v0
    v_and_b32 v156, 16, v0
    v_add_u32 v157, 8, v156
    v_cndmask_b32 v154, 0, v152, vcc
    v_cndmask_b32 v155, 0, v153, vcc
    v_min_u32 v157, 22, v157
    v_lshrrev_b32 v156, v156, v160
    v_lshrrev_b32 v157, v157, v160
    s_mov_b64 s[74:75], 0
    s_mov_b64 s[76:77], 0
    v_and_b32 v60, 1, v0
    v_lshlrev_b32 v60, 4, v60
    v_mov_b32 v62, 0x3f80
    v_lshlrev_b32 v60, v60, v62
    v_bfe_u32 v61, v0, 1, 2
    v_cmp_eq_u32 vcc, 0, v61
    s_nop 1
    v_cndmask_b32 v68, 0, v60, vcc
    v_cmp_eq_u32 vcc, 1, v61
    s_nop 1
    v_cndmask_b32 v69, 0, v60, vcc
    v_cmp_eq_u32 vcc, 2, v61
    s_nop 1
    v_cndmask_b32 v70, 0, v60, vcc
    v_cmp_eq_u32 vcc, 3, v61
    s_nop 1
    v_cndmask_b32 v71, 0, v60, vcc
    v_mov_b32 v59, 0x3f803f80
    s_mov_b32 s78, 0
    s_mov_b32 s79, -1
    s_mov_b32 s82, 0
    s_cmp_eq_u32 s33, 8
    s_cbranch_scc1 L_listen
    s_waitcnt vmcnt(0) lgkmcnt(0)
    s_mov_b64 exec, 1
    ds_add_u32 v4, v150 offset:96
    s_mov_b64 exec, -1
    s_cmp_ge_u32 s33, 4
    s_cbranch_scc1 L_hc
L_wa:
    ds_read_b64 v[60:61], v76 offset:192
    ds_read_b32 v64, v4 offset:96
    s_waitcnt lgkmcnt(0)
    v_cmp_eq_u32_e64 s[6:7], v60, v160
    v_cmp_eq_u32_e64 s[8:9], v61, v160
    s_andn2_b64 exec, s[6:7], s[74:75]
    s_cbranch_scc0 L_asa0
    global_load_dwordx4 v[44:47], v72, s[28:29] offset:0 sc1
    s_or_b64 s[74:75], s[74:75], exec
L_asa0:
    s_andn2_b64 exec, s[8:9], s[76:77]
    s_cbranch_scc0 L_asa1
    global_load_dwordx4 v[48:51], v72, s[28:29] offset:1024 sc1
    s_or_b64 s[76:77], s[76:77], exec
L_asa1:
    s_mov_b64 exec, -1
    s_add_u32 s82, s82, 1
    s_cmp_gt_u32 s82, 262144
    s_cbranch_scc1 L_wdone
    v_cmp_eq_u32 vcc, 9, v64
    s_cbranch_vccz L_wa
L_wdone:
    ds_read_b64_tr_b16 v[8:9], v80 offset:0
    ds_read_b64_tr_b16 v[10:11], v80 offset:256
    ds_read_b64_tr_b16 v[12:13], v80 offset:2048
    ds_read_b64_tr_b16 v[14:15], v80 offset:2304
    ds_read_b64_tr_b16 v[16:17], v80 offset:4096
    ds_read_b64_tr_b16 v[18:19], v80 offset:4352
    ds_read_b64_tr_b16 v[20:21], v80 offset:6144
    ds_read_b64_tr_b16 v[22:23], v80 offset:6400
    ds_read_b64_tr_b16 v[24:25], v80 offset:8192
    ds_read_b64_tr_b16 v[26:27], v80 offset:8448
    ds_read_b64_tr_b16 v[28:29], v80 offset:10240
    ds_read_b64_tr_b16 v[30:31], v80 offset:10496
    ds_read_b64_tr_b16 v[32:33], v80 offset:12288
    ds_read_b64_tr_b16 v[34:35], v80 offset:12544
    ds_read_b64_tr_b16 v[36:37], v80 offset:14336
    ds_read_b64_tr_b16 v[38:39], v80 offset:14592
    ds_read_b64_tr_b16 v[40:41], v80 offset:16384
    ds_read_b64_tr_b16 v[42:43], v80 offset:16640
    s_branch L_hc1
L_listen:
    s_load_dwordx8 s[48:55], s[26:27], 0 glc
    v_mov_b32 v62, 0
    v_mov_b32 v63, 0
    s_waitcnt vmcnt(0) lgkmcnt(0)
    s_mov_b64 exec, 1
    ds_add_u32 v4, v150 offset:96
    s_mov_b64 exec, -1
L_hp1:
    s_load_dwordx8 s[48:55], s[26:27], 0 glc
    v_writelane_b32 v62, s48, 0
    v_writelane_b32 v62, s49, 16
    v_writelane_b32 v62, s50, 32
    v_writelane_b32 v62, s51, 48
    v_writelane_b32 v63, s52, 0
    v_writelane_b32 v63, s53, 16
    v_writelane_b32 v63, s54, 32
    v_writelane_b32 v63, s55, 48
    v_mov_b32 v60, v62 row_newbcast:0 row_mask:0xf bank_mask:0xf
    s_nop 0
    v_mov_b32 v61, v63 row_newbcast:0 row_mask:0xf bank_mask:0xf
    ds_write_b64 v76, v[60:61] offset:192
    v_cmp_eq_u32_e64 s[6:7], v60, v160
    v_cmp_eq_u32_e64 s[8:9], v61, v160
    s_andn2_b64 exec, s[6:7], s[74:75]
    s_cbranch_scc0 L_asp0
    global_load_dwordx4 v[44:47], v72, s[28:29] offset:0 sc1
    s_or_b64 s[74:75], s[74:75], exec
L_asp0:
    s_andn2_b64 exec, s[8:9], s[76:77]
    s_cbranch_scc0 L_asp1
    global_load_dwordx4 v[48:51], v72, s[28:29] offset:1024 sc1
    s_or_b64 s[76:77], s[76:77], exec
L_asp1:
    s_mov_b64 exec, -1
    s_add_u32 s82, s82, 1
    s_cmp_gt_u32 s82, 1048576
    s_cbranch_scc1 L_hdone
    s_and_b64 s[34:35], s[74:75], s[76:77]
    s_cmp_eq_u64 s[34:35], -1
    s_cbranch_scc0 L_hp1
    v_mov_b32 v60, v160
    v_mov_b32 v61, v160
    ds_write_b64 v76, v[60:61] offset:192
    s_branch L_hdone
L_hc:
    ds_read_b64 v[60:61], v76 offset:192
    s_waitcnt lgkmcnt(0)
    v_cmp_eq_u32_e64 s[6:7], v60, v160
    v_cmp_eq_u32_e64 s[8:9], v61, v160
    s_andn2_b64 exec, s[6:7], s[74:75]
    s_cbranch_scc0 L_asc0
    global_load_dwordx4 v[44:47], v72, s[28:29] offset:0 sc1
    s_or_b64 s[74:75], s[74:75], exec
L_asc0:
    s_andn2_b64 exec, s[8:9], s[76:77]
    s_cbranch_scc0 L_asc1
    global_load_dwordx4 v[48:51], v72, s[28:29] offset:1024 sc1
    s_or_b64 s[76:77], s[76:77], exec
L_asc1:
    s_mov_b64 exec, -1
L_hc1:
    s_add_u32 s82, s82, 1
    s_cmp_gt_u32 s82, 1048576
    s_cbranch_scc1 L_hdone
    s_and_b64 s[34:35], s[74:75], s[76:77]
    s_cmp_eq_u64 s[34:35], -1
    s_cbranch_scc0 L_hc
L_hdone:
    s_cmp_ge_u32 s33, 4
    s_cbranch_scc1 L_nocs
    s_waitcnt lgkmcnt(12)
    v_mfma_f32_16x16x32_bf16 v[140:143], v[84:87], v[8:11], 0
    v_mfma_f32_16x16x32_bf16 v[140:143], v[84:87], v[12:15], v[140:143]
    v_mfma_f32_16x16x32_bf16 v[140:143], v[84:87], v[16:19], v[140:143]
    s_waitcnt lgkmcnt(6)
    v_mfma_f32_16x16x32_bf16 v[140:143], v[84:87], v[20:23], v[140:143]
    v_mfma_f32_16x16x32_bf16 v[140:143], v[84:87], v[24:27], v[140:143]
    v_mfma_f32_16x16x32_bf16 v[140:143], v[84:87], v[28:31], v[140:143]
    s_waitcnt lgkmcnt(0)
    v_mfma_f32_16x16x32_bf16 v[140:143], v[84:87], v[32:35], v[140:143]
    v_mfma_f32_16x16x32_bf16 v[140:143], v[84:87], v[36:39], v[140:143]
    v_mfma_f32_16x16x32_bf16 v[140:143], v[84:87], v[40:43], v[140:143]
L_nocs:
    s_mov_b32 s82, 0
L_pb:
    s_waitcnt vmcnt(0)
    v_mfma_f32_16x16x32_bf16 v[52:55], v[68:71], v[44:47], 0
    v_mfma_f32_16x16x32_bf16 v[52:55], v[68:71], v[48:51], v[52:55]
    v_max3_u32 v60, v44, v45, v46
    v_max3_u32 v60, v60, v47, v48
    v_max3_u32 v60, v60, v49, v50
    v_max_u32 v60, v60, v51
    v_cmp_eq_u32 vcc, -1, v60
    s_cbranch_vccnz L_pb_retry
L_pb_done:
    s_nop 1
    v_cvt_pk_bf16_f32 v56, v52, v53
    v_cvt_pk_bf16_f32 v57, v54, v55
    ds_write_b64 v73, v[56:57] offset:2048
    v_cndmask_b32_e64 v52, v59, v56, s[78:79]
    v_cndmask_b32_e64 v53, v59, v57, s[78:79]
    v_dot2_f32_bf16 v46, v56, v52, 0
    v_dot2_f32_bf16 v46, v57, v53, v46
    s_nop 2
    v_add_f32 v46, v46, v46 quad_perm:[1,0,3,2] row_mask:0xf bank_mask:0xf
    s_nop 1
    v_add_f32 v46, v46, v46 quad_perm:[2,3,0,1] row_mask:0xf bank_mask:0xf
    s_nop 1
    v_add_f32 v46, v46, v46 row_half_mirror row_mask:0xf bank_mask:0xf
    s_mov_b64 exec, s[64:65]
    ds_write_b32 v74, v46 offset:512
    s_mov_b64 exec, -1
    s_cmp_ge_u32 s33, 4
    s_cbranch_scc1 L_w2
    v_add_f32 v49, v140, v140 row_ror:8 row_mask:0xf bank_mask:0xf
    v_mov_b32 v47, 0xc0135761
    s_mov_b32 s34, 0xbdd2d3e8
    v_mul_f32 v49, 0x3ae38e39, v49
    v_mov_b32 v46, 0x2edbe6ff
    s_waitcnt lgkmcnt(0)
    s_barrier
    ds_read_b32 v44, v77 offset:512
    ds_read_b32 v45, v75 offset:768
    ds_read_b128 v[104:107], v78 offset:2048
    ds_read_b128 v[108:111], v78 offset:2112
    ds_read_b128 v[112:115], v78 offset:2176
    ds_read_b128 v[116:119], v78 offset:2240
    ds_read_b128 v[120:123], v78 offset:2304
    ds_read_b128 v[124:127], v78 offset:2368
    ds_read_b128 v[128:131], v78 offset:2432
    ds_read_b128 v[132:135], v78 offset:2496
    ds_read_b128 v[136:139], v78 offset:2560
    s_waitcnt lgkmcnt(8)
    v_mfma_f32_16x16x32_bf16 v[64:67], v[104:107], v[8:11], 0
    v_add_f32 v44, v44, v44 quad_perm:[1,0,3,2] row_mask:0xf bank_mask:0xf
    s_waitcnt lgkmcnt(7)
    v_mfma_f32_16x16x32_bf16 v[64:67], v[108:111], v[12:15], v[64:67]
    v_add_f32 v44, v44, v44 quad_perm:[2,3,0,1] row_mask:0xf bank_mask:0xf
    s_waitcnt lgkmcnt(6)
    v_mfma_f32_16x16x32_bf16 v[64:67], v[112:115], v[16:19], v[64:67]
    v_add_f32 v44, v44, v44 row_half_mirror row_mask:0xf bank_mask:0xf
    s_waitcnt lgkmcnt(5)
    v_mfma_f32_16x16x32_bf16 v[64:67], v[116:119], v[20:23], v[64:67]
    v_add_f32 v50, v44, v45
    v_add_f32 v45, v44, v45
    s_waitcnt lgkmcnt(4)
    v_mfma_f32_16x16x32_bf16 v[64:67], v[120:123], v[24:27], v[64:67]
    v_permlane16_swap_b32 v50, v45
    s_waitcnt lgkmcnt(3)
    v_mfma_f32_16x16x32_bf16 v[64:67], v[124:127], v[28:31], v[64:67]
    v_add_f32 v44, v50, v45
    v_add_f32 v45, v50, v45
    s_waitcnt lgkmcnt(2)
    v_mfma_f32_16x16x32_bf16 v[64:67], v[128:131], v[32:35], v[64:67]
    v_permlane32_swap_b32 v44, v45
    s_waitcnt lgkmcnt(1)
    v_mfma_f32_16x16x32_bf16 v[64:67], v[132:135], v[36:39], v[64:67]
    v_mul_f32 v50, v44, v44
    s_waitcnt lgkmcnt(0)
    v_mfma_f32_16x16x32_bf16 v[64:67], v[136:139], v[40:43], v[64:67]
    v_fmac_f32 v46, 0x3ae38ece, v45
    v_fmac_f32 v46, 0xb64a460c, v50
    v_max_f32 v46, 0x2edbe6ff, v46
    v_rsq_f32 v46, v46
    v_mul_f32 v44, v44, v49
    v_fma_f32 v44, -v44, v46, v81
    s_nop 1
    v_add_f32 v48, v66, v64 row_ror:8 row_mask:0xf bank_mask:0x3
    s_nop 1
    v_add_f32 v48, v65, v67 row_ror:8 row_mask:0xf bank_mask:0xc
    v_fmac_f32 v44, v48, v46
    v_mul_f32 v45, v44, v44
    v_fma_f32 v45, v45, s34, v47
    v_mul_f32 v45, v44, v45
    v_exp_f32 v45, v45
    s_nop 0
    v_add_f32 v45, 1.0, v45
    v_rcp_f32 v45, v45
    s_nop 0
    v_mul_f32 v44, v44, v45
    v_cvt_pk_bf16_f32 v44, v44, v44
    ds_write_b16 v79, v44 offset:256
    s_waitcnt lgkmcnt(0)
    s_barrier
    s_branch L_fin
L_w2:
    s_waitcnt lgkmcnt(0)
    s_barrier
    s_cmp_eq_u32 s33, 8
    s_cbranch_scc1 L_final
    ds_read_b64_tr_b16 v[8:9], v80 offset:0
    ds_read_b64_tr_b16 v[10:11], v80 offset:2048
    ds_read_b64_tr_b16 v[12:13], v80 offset:4096
    ds_read_b64_tr_b16 v[14:15], v80 offset:6144
    ds_read_b64_tr_b16 v[16:17], v80 offset:8192
    ds_read_b64_tr_b16 v[18:19], v80 offset:10240
    ds_read_b64_tr_b16 v[20:21], v80 offset:12288
    ds_read_b64_tr_b16 v[22:23], v80 offset:14336
    ds_read_b64_tr_b16 v[24:25], v80 offset:16384
    ds_read_b64_tr_b16 v[26:27], v80 offset:18432
    ds_read_b64_tr_b16 v[28:29], v80 offset:20480
    ds_read_b64_tr_b16 v[30:31], v80 offset:22528
    ds_read_b64_tr_b16 v[32:33], v80 offset:24576
    ds_read_b64_tr_b16 v[34:35], v80 offset:26624
    ds_read_b64_tr_b16 v[36:37], v80 offset:28672
    ds_read_b64_tr_b16 v[38:39], v80 offset:30720
    ds_read_b64_tr_b16 v[40:41], v80 offset:32768
    ds_read_b64_tr_b16 v[42:43], v80 offset:34816
    s_waitcnt lgkmcnt(0)
    s_barrier
    ds_read_b128 v[104:107], v88
    ds_read_b128 v[108:111], v89
    ds_read_b128 v[112:115], v90
    ds_read_b128 v[116:119], v91
    ds_read_b128 v[120:123], v92
    ds_read_b128 v[124:127], v93
    ds_read_b128 v[128:131], v94
    ds_read_b128 v[132:135], v95
    s_waitcnt lgkmcnt(7)
    v_mfma_f32_16x16x32_bf16 v[68:71], v[40:43], v[104:107], 0
    v_mfma_f32_16x16x32_bf16 v[64:67], v[8:11], v[104:107], 0
    s_waitcnt lgkmcnt(6)
    v_mfma_f32_16x16x32_bf16 v[64:67], v[12:15], v[108:111], v[64:67]
    s_waitcnt lgkmcnt(5)
    v_mfma_f32_16x16x32_bf16 v[64:67], v[16:19], v[112:115], v[64:67]
    s_waitcnt lgkmcnt(4)
    v_mfma_f32_16x16x32_bf16 v[64:67], v[20:23], v[116:119], v[64:67]
    s_waitcnt lgkmcnt(3)
    v_mfma_f32_16x16x32_bf16 v[64:67], v[24:27], v[120:123], v[64:67]
    s_waitcnt lgkmcnt(2)
    v_mfma_f32_16x16x32_bf16 v[64:67], v[28:31], v[124:127], v[64:67]
    s_waitcnt lgkmcnt(1)
    v_mfma_f32_16x16x32_bf16 v[64:67], v[32:35], v[128:131], v[64:67]
    s_waitcnt lgkmcnt(0)
    v_mfma_f32_16x16x32_bf16 v[64:67], v[36:39], v[132:135], v[64:67]
    v_bfi_b32 v69, s66, v156, v69
    v_bfi_b32 v71, s66, v157, v71
    s_mov_b32 exec_lo, 0x30003
    s_mov_b32 exec_hi, 0x30003
    global_store_dwordx4 v77, v[68:71], s[28:29] offset:1024 sc1
    s_mov_b64 exec, -1
    s_nop 1
    v_bfi_b32 v65, s66, v156, v65
    v_bfi_b32 v67, s66, v157, v67
    global_store_dwordx4 v77, v[64:67], s[28:29] sc1
    s_waitcnt vmcnt(0)
    s_barrier
    s_branch L_fin
L_final:
    s_cmp_eq_u32 s61, 0
    s_cbranch_scc0 L_noep
    s_mov_b64 exec, 1
    global_store_dword v161, v160, s[28:29] sc1
    s_mov_b64 exec, -1
L_noep:
    ds_read_u16 v64, v96 offset:2048
    s_waitcnt lgkmcnt(0)
    v_lshlrev_b32 v64, 16, v64
    v_add_f32 v98, v98, v64
    s_barrier
    s_barrier
    buffer_load_dwordx4 v[44:47], v97, s[40:43], s68 offen sc1
    buffer_load_dwordx4 v[48:51], v97, s[40:43], s69 offen sc1
    buffer_load_dwordx4 v[52:55], v97, s[40:43], s70 offen sc1
    buffer_load_dwordx4 v[56:59], v97, s[40:43], s71 offen sc1
    buffer_load_dwordx4 v[60:63], v97, s[40:43], s72 offen sc1
    s_waitcnt vmcnt(4)
    v_xor_b32 v45, v152, v45
    v_xor_b32 v47, v153, v47
    v_or_b32 v64, v45, v47
    s_waitcnt vmcnt(3)
    v_xor_b32 v49, v152, v49
    v_xor_b32 v51, v153, v51
    v_or3_b32 v64, v49, v51, v64
    v_pk_add_f32 v[68:69], v[44:45], v[48:49]
    v_pk_add_f32 v[70:71], v[46:47], v[50:51]
    s_waitcnt vmcnt(2)
    v_xor_b32 v53, v152, v53
    v_xor_b32 v55, v153, v55
    v_or3_b32 v64, v53, v55, v64
    v_pk_add_f32 v[68:69], v[68:69], v[52:53]
    v_pk_add_f32 v[70:71], v[70:71], v[54:55]
    s_waitcnt vmcnt(1)
    v_xor_b32 v57, v152, v57
    v_xor_b32 v59, v153, v59
    v_or3_b32 v64, v57, v59, v64
    v_pk_add_f32 v[68:69], v[68:69], v[56:57]
    v_pk_add_f32 v[70:71], v[70:71], v[58:59]
    s_waitcnt vmcnt(0)
    v_xor_b32 v61, v154, v61
    v_xor_b32 v63, v155, v63
    v_or3_b32 v64, v61, v63, v64
    v_and_b32 v64, s66, v64
    v_cmp_ne_u32 vcc, 0, v64
    v_pk_add_f32 v[68:69], v[68:69], v[60:61]
    v_pk_add_f32 v[70:71], v[70:71], v[62:63]
    s_cbranch_vccnz L_pc_first
L_pc_done:
    v_permlane32_swap_b32 v68, v69
    v_permlane32_swap_b32 v70, v71
    v_add_f32 v44, v68, v69
    v_add_f32 v46, v70, v71
    s_nop 1
    v_permlane16_swap_b32 v44, v46
    v_add_f32 v44, v44, v46
    s_nop 1
    v_add_f32 v44, v44, v44 quad_perm:[2,3,0,1] row_mask:0xf bank_mask:0xf
    s_nop 1
    v_add_f32 v44, v44, v44 row_ror:4 row_mask:0xf bank_mask:0xf
    s_nop 1
    v_add_f32 v44, v44, v44 row_ror:8 row_mask:0xf bank_mask:0xf
    v_add_f32 v44, v98, v44
    v_cvt_pk_bf16_f32 v44, v44, v44
    s_mov_b32 exec_lo, 0x30003
    s_mov_b32 exec_hi, 0x30003
    global_store_short v96, v44, s[24:25]
    s_endpgm
L_gs:
    s_mov_b32 s82, 0
L_sg:
    ds_read_b32 v152, v4 offset:104
    s_add_u32 s82, s82, 1
    s_cmp_gt_u32 s82, 4194304
    s_cbranch_scc1 L_sg_done
    s_waitcnt lgkmcnt(0)
    v_cmp_ne_u32 vcc, 0, v152
    s_cbranch_vccnz L_sg_done
    s_sleep 1
    s_branch L_sg
L_sg_done:
    v_readfirstlane_b32 s63, v152
    s_nop 0
    s_cmp_eq_u32 s63, 2
    s_cbranch_scc1 L_gsok
    v_mov_b32 v93, v76
    v_mov_b32 v94, v91
    s_branch L_gsok
L_pa_again:
    s_cmp_gt_u32 s82, 65536
    s_cbranch_scc1 L_pa_done
    s_nop 7
    s_branch L_pa_retry
L_pb_retry:
    s_add_u32 s82, s82, 1
    s_cmp_gt_u32 s82, 65536
    s_cbranch_scc1 L_pb_done
    s_sleep 1
    s_mov_b64 exec, vcc
    global_load_dwordx4 v[44:47], v72, s[28:29] offset:0 sc1
    global_load_dwordx4 v[48:51], v72, s[28:29] offset:1024 sc1
    s_mov_b64 exec, -1
    s_branch L_pb
L_pc_first:
    s_mov_b32 s82, 0
L_pc_retry:
    v_bitop3_b32 v64, v45, v47, s66 bitop3:0xa8
    v_cmp_ne_u32_e64 s[48:49], 0, v64
    v_bitop3_b32 v64, v49, v51, s66 bitop3:0xa8
    v_cmp_ne_u32_e64 s[50:51], 0, v64
    v_bitop3_b32 v64, v53, v55, s66 bitop3:0xa8
    v_cmp_ne_u32_e64 s[52:53], 0, v64
    v_bitop3_b32 v64, v57, v59, s66 bitop3:0xa8
    v_cmp_ne_u32_e64 s[54:55], 0, v64
    v_bitop3_b32 v64, v61, v63, s66 bitop3:0xa8
    v_cmp_ne_u32_e64 s[56:57], 0, v64
    s_or_b64 vcc, s[48:49], s[50:51]
    s_or_b64 vcc, vcc, s[52:53]
    s_or_b64 vcc, vcc, s[54:55]
    s_or_b64 vcc, vcc, s[56:57]
    s_cbranch_scc0 L_pc_out
    s_add_u32 s82, s82, 1
    s_cmp_gt_u32 s82, 65536
    s_cbranch_scc1 L_pc_out
    s_cmp_eq_u64 s[48:49], 0
    s_cbranch_scc1 L_pc_i0
    buffer_load_dwordx4 v[44:47], v97, s[40:43], s68 offen sc1
L_pc_i0:
    s_cmp_eq_u64 s[50:51], 0
    s_cbranch_scc1 L_pc_i1
    buffer_load_dwordx4 v[48:51], v97, s[40:43], s69 offen sc1
L_pc_i1:
    s_cmp_eq_u64 s[52:53], 0
    s_cbranch_scc1 L_pc_i2
    buffer_load_dwordx4 v[52:55], v97, s[40:43], s70 offen sc1
L_pc_i2:
    s_cmp_eq_u64 s[54:55], 0
    s_cbranch_scc1 L_pc_i3
    buffer_load_dwordx4 v[56:59], v97, s[40:43], s71 offen sc1
L_pc_i3:
    s_cmp_eq_u64 s[56:57], 0
    s_cbranch_scc1 L_pc_i4
    buffer_load_dwordx4 v[60:63], v97, s[40:43], s72 offen sc1
L_pc_i4:
    s_waitcnt vmcnt(0)
    s_cmp_eq_u64 s[48:49], 0
    s_cbranch_scc1 L_pc_c0
    v_xor_b32 v45, v152, v45
    v_xor_b32 v47, v153, v47
L_pc_c0:
    s_cmp_eq_u64 s[50:51], 0
    s_cbranch_scc1 L_pc_c1
    v_xor_b32 v49, v152, v49
    v_xor_b32 v51, v153, v51
L_pc_c1:
    s_cmp_eq_u64 s[52:53], 0
    s_cbranch_scc1 L_pc_c2
    v_xor_b32 v53, v152, v53
    v_xor_b32 v55, v153, v55
L_pc_c2:
    s_cmp_eq_u64 s[54:55], 0
    s_cbranch_scc1 L_pc_c3
    v_xor_b32 v57, v152, v57
    v_xor_b32 v59, v153, v59
L_pc_c3:
    s_cmp_eq_u64 s[56:57], 0
    s_cbranch_scc1 L_pc_c4
    v_xor_b32 v61, v154, v61
    v_xor_b32 v63, v155, v63
L_pc_c4:
    s_branch L_pc_retry
L_pc_out:
    v_pk_add_f32 v[68:69], v[44:45], v[48:49]
    v_pk_add_f32 v[70:71], v[46:47], v[50:51]
    v_pk_add_f32 v[68:69], v[68:69], v[52:53]
    v_pk_add_f32 v[70:71], v[70:71], v[54:55]
    v_pk_add_f32 v[68:69], v[68:69], v[56:57]
    v_pk_add_f32 v[70:71], v[70:71], v[58:59]
    v_pk_add_f32 v[68:69], v[68:69], v[60:61]
    v_pk_add_f32 v[70:71], v[70:71], v[62:63]
    s_nop 0
    s_branch L_pc_done
L_fin:
L_end:
    s_endpgm
.if L_end-L_pc < 18975
.error "code prefetch would read past the code"
.endif
.section .rodata,"a"
.p2align 6
.amdhsa_kernel sequential_preLN__sliding_block_cached__mixer_channel_mlp__decode_kernel
  .amdhsa_next_free_vgpr 168
  .amdhsa_next_free_sgpr 102
  .amdhsa_accum_offset 168
  .amdhsa_group_segment_fixed_size 0
  .amdhsa_kernarg_size 104
  .amdhsa_user_sgpr_count 2
  .amdhsa_user_sgpr_kernarg_segment_ptr 1
  .amdhsa_system_sgpr_workgroup_id_x 1
  .amdhsa_float_denorm_mode_32 3
.end_amdhsa_kernel
```
